```python
import torch

def _softmax(x, axis=-1):
    return torch.softmax(x, dim=axis)

def _gelu(x):
    return torch.nn.functional.gelu(x, approximate='tanh')

def _silu(x):
    return torch.nn.functional.silu(x)

def _sigmoid(x):
    return torch.sigmoid(x)

def _layernorm(x, axis=-1, eps=1e-05):
    m = x.mean(dim=axis, keepdim=True)
    v = x.var(dim=axis, keepdim=True, unbiased=False)
    return (x - m) / torch.sqrt(v + eps)

def _scatter_add(tgt, idx, src, axis=0):
    return tgt.clone().index_add_(axis, idx, src)

def _segment_sum(src, seg, n):
    out = torch.zeros((n,) + src.shape[1:], dtype=src.dtype)
    return out.index_add_(0, seg, src)

def _pad(x, pw):
    flat = tuple((v for pair in reversed(pw) for v in pair))
    return torch.nn.functional.pad(x, flat)
kernel_name = 'adaLN_cond__sliding_block_cached__glu_gated_reglu__decode'

def setup_inputs():

    _w = lambda a: (lambda t: t.to(torch.bfloat16) if t.is_floating_point() else t)(torch.as_tensor(a))

    def _A_setup():
        B, Sq, D = (4, 1, 512)
        Hq, Hkv, Sk, Dh = (32, 8, 4096, 128)
        assert Hq % Hkv == 0, (Hq, Hkv)
        return {'x': _w((lambda *s: torch.randn(*s, dtype=torch.bfloat16) * 0.1)(B, Sq, D)), 'k_cache': _w((lambda *s: torch.randn(*s, dtype=torch.bfloat16) * 0.8)(B, Hkv, Sk, Dh)), 'v_cache': _w((lambda *s: torch.randn(*s, dtype=torch.bfloat16) * 3.2)(B, Hkv, Sk, Dh)), 'wq': _w((lambda *s: torch.randn(*s, dtype=torch.bfloat16) * 0.8)(D, Hq * Dh) * D ** (-0.5)), 'wo': _w((lambda *s: torch.randn(*s, dtype=torch.bfloat16) * 3.2)(Hq * Dh, D) * (Hq * Dh) ** (-0.5))}
    _A_in = _A_setup()

    def _B_setup():
        B, S, D, F = (4, 1, 512, 1792)
        return {'x': _w((lambda *s: torch.randn(*s, dtype=torch.bfloat16) * 0.1)(B, S, D)), 'W_gate': _w((lambda *s: torch.randn(*s, dtype=torch.bfloat16) * 3.2)(D, F) * (2.0 / D) ** 0.5), 'W_up': _w((lambda *s: torch.randn(*s, dtype=torch.bfloat16) * 3.2)(D, F) * (2.0 / D) ** 0.5), 'W_down': _w((lambda *s: torch.randn(*s, dtype=torch.bfloat16) * 3.2)(F, D) * (1.0 / F) ** 0.5)}
    _B_in = _B_setup()
    return {'A_x': _A_in['x'], 'A_k_cache': _A_in['k_cache'], 'A_v_cache': _A_in['v_cache'], 'A_wq': _A_in['wq'], 'A_wo': _A_in['wo'], 'B_x': _B_in['x'], 'B_W_gate': _B_in['W_gate'], 'B_W_up': _B_in['W_up'], 'B_W_down': _B_in['W_down'], 'c': _w((lambda *s: torch.randn(*s, dtype=torch.bfloat16) * 0.8)(4, 512) * 8.0), 'w_mod': _w((lambda *s: torch.randn(*s, dtype=torch.bfloat16) * 0.8)(512, 6 * 512) * 512 ** (-0.5) * 8.0)}

def reference(A_x, A_k_cache, A_v_cache, A_wq, A_wo, B_x, B_W_gate, B_W_up, B_W_down, c, w_mod):

    def _A_ref(x, k_cache, v_cache, wq, wo):
        B, Sq, D = x.shape
        Hq, Dh = (32, 128)
        Hkv, Sk = (k_cache.shape[1], k_cache.shape[2])
        W = min(4096, max(256, Sk // 4))
        rep = Hq // Hkv
        q = (lambda x, *d: x.permute(*d))((x @ wq).reshape(B, Sq, Hq, Dh), 0, 2, 1, 3)
        k = (lambda x, n, axis: torch.repeat_interleave(x, n, dim=axis))(k_cache[:, :, Sk - W:, :], rep, axis=1)
        v = (lambda x, n, axis: torch.repeat_interleave(x, n, dim=axis))(v_cache[:, :, Sk - W:, :], rep, axis=1)
        scores = torch.einsum('bhqd,bhkd->bhqk', q, k) * Dh ** (-0.5)
        p = _softmax(scores, axis=-1)
        o = torch.einsum('bhqk,bhkd->bhqd', p, v)
        return (lambda x, *d: x.permute(*d))(o, 0, 2, 1, 3).reshape(B, Sq, Hq * Dh) @ wo

    def _B_ref(x, W_gate, W_up, W_down):
        gate = torch.einsum('bsd,df->bsf', x, W_gate)
        up = torch.einsum('bsd,df->bsf', x, W_up)
        gate = gate * (lambda x, dt: x.to(dt))(gate > 0, gate.dtype)
        h = gate * up
        return torch.einsum('bsf,fd->bsd', h, W_down)
    x = A_x
    mod = (_silu(c) @ w_mod).reshape(c.shape[0], 6, 1, -1)
    sa, ca, ga, sb, cb, gb = (mod[:, 0].clone(), mod[:, 1].clone(), mod[:, 2].clone(), mod[:, 3].clone(), mod[:, 4].clone(), mod[:, 5].clone())
    h = _layernorm(x, axis=-1) * (1 + ca) + sa
    x = x + ga * _A_ref(h, A_k_cache, A_v_cache, A_wq, A_wo)
    h = _layernorm(x, axis=-1) * (1 + cb) + sb
    x = x + gb * _B_ref(h, B_W_gate, B_W_up, B_W_down)
    return x
```

```asm
; @launch grid=(256,1,1) block=(512,1,1) lds=148480
.amdgcn_target "amdgcn-amd-amdhsa--gfx950"
.text
.globl adaLN_cond__sliding_block_cached__glu_gated_reglu__decode_kernel
.p2align 8
.type adaLN_cond__sliding_block_cached__glu_gated_reglu__decode_kernel,@function
adaLN_cond__sliding_block_cached__glu_gated_reglu__decode_kernel:
    s_cmp_ge_u32 s2, 256
    s_cbranch_scc1 L_END
    s_load_dwordx16 s[16:31], s[0:1], 0
    s_load_dwordx8 s[32:39], s[0:1], 64
    s_load_dwordx4 s[40:43], s[0:1], 96
    v_lshrrev_b32 v2, 6, v0
    v_and_b32 v1, 63, v0
    s_and_b32 s4, s2, 7
    v_readfirstlane_b32 s3, v2
    s_lshr_b32 s5, s2, 3
    s_mov_b32 s52, 0xffff0000
    s_mov_b32 s56, 0
    s_mov_b32 s62, 0x000f000f
    s_mov_b32 s63, 0x000f000f
    s_cmp_eq_u32 s3, 7
    s_cbranch_scc0 L_nopf
    s_getpc_b64 s[8:9]
L_pc:
    s_and_b32 s57, s5, 7
    s_lshl_b32 s57, s57, 12
    v_lshlrev_b32 v2, 6, v1
    v_add_u32 v2, s57, v2
    v_min_u32 v2, L_CODE_END-L_pc-4, v2
    global_load_dword v247, v2, s[8:9]
L_nopf:
    s_cmp_lt_u32 s5, 16
    s_cbranch_scc1 L_ATT
    s_cmp_lt_u32 s5, 24
    s_cbranch_scc1 L_QP
    s_lshl_b32 s66, s4, 3
    s_add_u32 s66, s66, s5
    s_sub_u32 s66, s66, 24
    s_cmp_ge_u32 s66, 44
    s_cbranch_scc1 L_MODB
    s_cmp_ge_u32 s66, 16
    s_cbranch_scc1 L_FFN
    s_mov_b32 s44, s66
    v_lshlrev_b32 v4, 3, v0
    v_lshrrev_b32 v5, 3, v1
    s_mov_b32 s57, 6144
    v_mul_lo_u32 v20, s57, v5
    v_bfe_u32 v5, v1, 1, 2
    v_bfe_u32 v6, v1, 4, 1
    v_xor_b32 v5, v5, v6
    v_lshl_add_u32 v20, v5, 5, v20
    v_and_b32 v5, 1, v1
    v_lshl_add_u32 v20, v5, 4, v20
    v_xor_b32 v21, 64, v20
    v_mov_b32 v22, v20
    v_mov_b32 v23, v21
    s_mul_i32 s46, s3, 393216
    s_lshl_b32 s47, s44, 7
    s_add_u32 s46, s46, s47
    s_lshl_b32 s67, s3, 13
    s_add_u32 s67, s67, 17408
    s_waitcnt lgkmcnt(0)
    s_load_dword s7, s[42:43], 0
    s_add_u32 s8, s36, s46
    s_addc_u32 s9, s37, 0
    s_add_u32 s46, s46, 4608
    s_add_u32 s12, s36, s46
    s_addc_u32 s13, s37, 0
    global_load_dwordx2 v[2:3], v4, s[34:35]
    s_barrier
    s_cmp_lt_u32 s3, 4
    s_cbranch_scc0 L_moda_hi
    s_mov_b32 m0, s67
    s_nop 0
    global_load_lds_dwordx4 v20, s[8:9] nt
    s_add_u32 m0, s67, 1024
    v_add_u32 v21, 49152, v21
    global_load_lds_dwordx4 v21, s[8:9] nt
    s_add_u32 m0, s67, 2048
    v_add_u32 v20, 98304, v20
    global_load_lds_dwordx4 v20, s[8:9] nt
    s_add_u32 m0, s67, 3072
    v_add_u32 v21, 98304, v21
    global_load_lds_dwordx4 v21, s[8:9] nt
    s_add_u32 m0, s67, 4096
    v_add_u32 v20, 98304, v20
    global_load_lds_dwordx4 v20, s[8:9] nt
    s_add_u32 m0, s67, 5120
    v_add_u32 v21, 98304, v21
    global_load_lds_dwordx4 v21, s[8:9] nt
    s_add_u32 m0, s67, 6144
    v_add_u32 v20, 98304, v20
    global_load_lds_dwordx4 v20, s[8:9] nt
    s_add_u32 m0, s67, 7168
    v_add_u32 v21, 98304, v21
    global_load_lds_dwordx4 v21, s[8:9] nt
    s_mov_b32 s53, 0x3fb8aa3b
    s_mov_b32 s54, 0xbfb8aa3b
    s_mov_b32 s55, 0x3db504f3
    s_mov_b32 s68, 0x00003f80
    s_mov_b32 s69, 0x3f800000
    v_lshrrev_b32 v4, 4, v1
    v_bfe_u32 v5, v1, 2, 2
    v_lshl_add_u32 v200, v4, 3, v5
    v_lshlrev_b32 v200, 7, v200
    v_and_b32 v4, 1, v4
    v_lshrrev_b32 v5, 1, v5
    v_lshl_add_u32 v4, v4, 1, v5
    s_and_b32 s57, s3, 3
    v_xor_b32 v4, s57, v4
    v_lshl_add_u32 v200, v4, 5, v200
    v_bfe_u32 v4, v1, 1, 1
    v_lshl_add_u32 v200, v4, 4, v200
    v_and_b32 v4, 1, v1
    v_lshl_add_u32 v200, v4, 3, v200
    v_add_u32 v200, 17408, v200
    v_add_u32 v201, 65536, v200
    v_and_b32 v4, 3, v1
    v_mul_u32_u24 v204, 1088, v4
    v_lshrrev_b32 v4, 4, v1
    v_lshl_add_u32 v204, v4, 4, v204
    v_and_b32 v4, 3, v1
    v_lshlrev_b32 v206, 6, v4
    v_lshrrev_b32 v4, 4, v1
    v_lshl_add_u32 v206, v4, 4, v206
    s_and_b32 s57, s3, 3
    s_lshl_b32 s57, s57, 8
    v_add_u32 v206, s57, v206
    s_lshl_b32 s46, s44, 10
    s_add_u32 s46, s46, 8192
    s_add_u32 s10, s42, s46
    s_addc_u32 s11, s43, 0
    s_add_u32 s46, s46, 36864
    s_add_u32 s14, s42, s46
    s_addc_u32 s15, s43, 0
    s_waitcnt vmcnt(8)
    v_lshlrev_b32 v8, 16, v2
    v_and_b32 v9, s52, v2
    v_lshlrev_b32 v10, 16, v3
    v_and_b32 v11, s52, v3
    v_mul_f32 v12, s54, v8
    v_mul_f32 v13, s54, v9
    v_mul_f32 v14, s54, v10
    v_mul_f32 v15, s54, v11
    v_exp_f32 v12, v12
    v_exp_f32 v13, v13
    v_exp_f32 v14, v14
    v_exp_f32 v15, v15
    v_add_f32 v12, 1.0, v12
    v_add_f32 v13, 1.0, v13
    v_add_f32 v14, 1.0, v14
    v_add_f32 v15, 1.0, v15
    v_rcp_f32 v40, v12
    v_rcp_f32 v41, v13
    v_rcp_f32 v42, v14
    v_rcp_f32 v43, v15
    v_mul_f32 v44, v8, v40
    v_mul_f32 v45, v9, v41
    v_mul_f32 v46, v10, v42
    v_mul_f32 v47, v11, v43
    v_fma_f32 v12, -v44, v12, v8
    v_fma_f32 v13, -v45, v13, v9
    v_fma_f32 v14, -v46, v14, v10
    v_fma_f32 v15, -v47, v15, v11
    v_mul_f32 v12, v12, v40
    v_mul_f32 v13, v13, v41
    v_mul_f32 v14, v14, v42
    v_mul_f32 v15, v15, v43
    v_cmp_neq_f32 vcc, 0, v40
    s_nop 1
    v_cndmask_b32 v12, 0, v12, vcc
    v_cmp_neq_f32 vcc, 0, v41
    s_nop 1
    v_cndmask_b32 v13, 0, v13, vcc
    v_cmp_neq_f32 vcc, 0, v42
    s_nop 1
    v_cndmask_b32 v14, 0, v14, vcc
    v_cmp_neq_f32 vcc, 0, v43
    s_nop 1
    v_cndmask_b32 v15, 0, v15, vcc
    v_add_f32 v8, v44, v12
    v_add_f32 v9, v45, v13
    v_add_f32 v10, v46, v14
    v_add_f32 v11, v47, v15
    v_cvt_pk_bf16_f32 v12, v8, v9
    v_cvt_pk_bf16_f32 v13, v10, v11
    v_lshrrev_b32 v14, 7, v0
    v_and_b32 v15, 127, v0
    v_mul_u32_u24 v16, 1088, v14
    v_lshl_add_u32 v16, v15, 3, v16
    ds_write_b64 v16, v[12:13] offset:0
    s_waitcnt lgkmcnt(0)
    s_mul_i32 s6, s7, 1664525
    s_add_u32 s6, s6, 1013904223
    v_mov_b32 v37, s6
    v_mov_b32 v39, s6
    s_barrier
    ds_read_b128 v[128:131], v204 offset:0
    ds_read_b128 v[132:135], v204 offset:64
    ds_read_b128 v[136:139], v204 offset:128
    ds_read_b128 v[140:143], v204 offset:192
    ds_read_b128 v[144:147], v204 offset:256
    ds_read_b128 v[148:151], v204 offset:320
    ds_read_b128 v[152:155], v204 offset:384
    ds_read_b128 v[156:159], v204 offset:448
    s_waitcnt lgkmcnt(7)
    ds_read_b128 v[160:163], v204 offset:512
    ds_read_b128 v[164:167], v204 offset:576
    ds_read_b128 v[168:171], v204 offset:640
    ds_read_b128 v[172:175], v204 offset:704
    ds_read_b128 v[176:179], v204 offset:768
    ds_read_b128 v[180:183], v204 offset:832
    ds_read_b128 v[184:187], v204 offset:896
    ds_read_b128 v[188:191], v204 offset:960
    s_branch L_moda_j
L_moda_hi:
    s_mov_b32 s53, 0x3fb8aa3b
    s_mov_b32 s54, 0xbfb8aa3b
    s_mov_b32 s55, 0x3db504f3
    s_mov_b32 s68, 0x00003f80
    s_mov_b32 s69, 0x3f800000
    s_waitcnt vmcnt(0)
    v_lshlrev_b32 v8, 16, v2
    v_and_b32 v9, s52, v2
    v_lshlrev_b32 v10, 16, v3
    v_and_b32 v11, s52, v3
    v_mul_f32 v12, s54, v8
    v_mul_f32 v13, s54, v9
    v_mul_f32 v14, s54, v10
    v_mul_f32 v15, s54, v11
    v_exp_f32 v12, v12
    v_exp_f32 v13, v13
    v_exp_f32 v14, v14
    v_exp_f32 v15, v15
    v_add_f32 v12, 1.0, v12
    v_add_f32 v13, 1.0, v13
    v_add_f32 v14, 1.0, v14
    v_add_f32 v15, 1.0, v15
    v_rcp_f32 v40, v12
    v_rcp_f32 v41, v13
    v_rcp_f32 v42, v14
    v_rcp_f32 v43, v15
    v_mul_f32 v44, v8, v40
    v_mul_f32 v45, v9, v41
    v_mul_f32 v46, v10, v42
    v_mul_f32 v47, v11, v43
    v_fma_f32 v12, -v44, v12, v8
    v_fma_f32 v13, -v45, v13, v9
    v_fma_f32 v14, -v46, v14, v10
    v_fma_f32 v15, -v47, v15, v11
    v_mul_f32 v12, v12, v40
    v_mul_f32 v13, v13, v41
    v_mul_f32 v14, v14, v42
    v_mul_f32 v15, v15, v43
    v_cmp_neq_f32 vcc, 0, v40
    s_nop 1
    v_cndmask_b32 v12, 0, v12, vcc
    v_cmp_neq_f32 vcc, 0, v41
    s_nop 1
    v_cndmask_b32 v13, 0, v13, vcc
    v_cmp_neq_f32 vcc, 0, v42
    s_nop 1
    v_cndmask_b32 v14, 0, v14, vcc
    v_cmp_neq_f32 vcc, 0, v43
    s_nop 1
    v_cndmask_b32 v15, 0, v15, vcc
    v_add_f32 v8, v44, v12
    v_add_f32 v9, v45, v13
    v_add_f32 v10, v46, v14
    v_add_f32 v11, v47, v15
    v_cvt_pk_bf16_f32 v12, v8, v9
    v_cvt_pk_bf16_f32 v13, v10, v11
    v_lshrrev_b32 v14, 7, v0
    v_and_b32 v15, 127, v0
    v_mul_u32_u24 v16, 1088, v14
    v_lshl_add_u32 v16, v15, 3, v16
    ds_write_b64 v16, v[12:13] offset:0
    s_waitcnt lgkmcnt(0)
    s_barrier
    s_mov_b32 m0, s67
    s_nop 0
    global_load_lds_dwordx4 v20, s[8:9] nt
    s_add_u32 m0, s67, 1024
    v_add_u32 v21, 49152, v21
    global_load_lds_dwordx4 v21, s[8:9] nt
    s_add_u32 m0, s67, 2048
    v_add_u32 v20, 98304, v20
    global_load_lds_dwordx4 v20, s[8:9] nt
    s_add_u32 m0, s67, 3072
    v_add_u32 v21, 98304, v21
    global_load_lds_dwordx4 v21, s[8:9] nt
    s_add_u32 m0, s67, 4096
    v_add_u32 v20, 98304, v20
    global_load_lds_dwordx4 v20, s[8:9] nt
    s_add_u32 m0, s67, 5120
    v_add_u32 v21, 98304, v21
    global_load_lds_dwordx4 v21, s[8:9] nt
    s_add_u32 m0, s67, 6144
    v_add_u32 v20, 98304, v20
    global_load_lds_dwordx4 v20, s[8:9] nt
    s_add_u32 m0, s67, 7168
    v_add_u32 v21, 98304, v21
    global_load_lds_dwordx4 v21, s[8:9] nt
    s_mov_b32 s53, 0x3fb8aa3b
    s_mov_b32 s54, 0xbfb8aa3b
    s_mov_b32 s55, 0x3db504f3
    s_mov_b32 s68, 0x00003f80
    s_mov_b32 s69, 0x3f800000
    v_lshrrev_b32 v4, 4, v1
    v_bfe_u32 v5, v1, 2, 2
    v_lshl_add_u32 v200, v4, 3, v5
    v_lshlrev_b32 v200, 7, v200
    v_and_b32 v4, 1, v4
    v_lshrrev_b32 v5, 1, v5
    v_lshl_add_u32 v4, v4, 1, v5
    s_and_b32 s57, s3, 3
    v_xor_b32 v4, s57, v4
    v_lshl_add_u32 v200, v4, 5, v200
    v_bfe_u32 v4, v1, 1, 1
    v_lshl_add_u32 v200, v4, 4, v200
    v_and_b32 v4, 1, v1
    v_lshl_add_u32 v200, v4, 3, v200
    v_add_u32 v200, 17408, v200
    v_add_u32 v201, 65536, v200
    v_and_b32 v4, 3, v1
    v_mul_u32_u24 v204, 1088, v4
    v_lshrrev_b32 v4, 4, v1
    v_lshl_add_u32 v204, v4, 4, v204
    v_and_b32 v4, 3, v1
    v_lshlrev_b32 v206, 6, v4
    v_lshrrev_b32 v4, 4, v1
    v_lshl_add_u32 v206, v4, 4, v206
    s_and_b32 s57, s3, 3
    s_lshl_b32 s57, s57, 8
    v_add_u32 v206, s57, v206
    s_lshl_b32 s46, s44, 10
    s_add_u32 s46, s46, 8192
    s_add_u32 s10, s42, s46
    s_addc_u32 s11, s43, 0
    s_add_u32 s46, s46, 36864
    s_add_u32 s14, s42, s46
    s_addc_u32 s15, s43, 0
    s_waitcnt lgkmcnt(0)
    s_mul_i32 s6, s7, 1664525
    s_add_u32 s6, s6, 1013904223
L_moda_j:
    s_waitcnt vmcnt(0) lgkmcnt(0)
    s_barrier
    s_cmp_lt_u32 s3, 4
    s_cbranch_scc0 L_moda_b
    ds_read_b64_tr_b16 v[64:65], v200 offset:0
    ds_read_b64_tr_b16 v[66:67], v200 offset:512
    ds_read_b64_tr_b16 v[68:69], v200 offset:4096
    ds_read_b64_tr_b16 v[70:71], v200 offset:4608
    ds_read_b64_tr_b16 v[72:73], v200 offset:8192
    ds_read_b64_tr_b16 v[74:75], v200 offset:8704
    ds_read_b64_tr_b16 v[76:77], v200 offset:12288
    ds_read_b64_tr_b16 v[78:79], v200 offset:12800
    ds_read_b64_tr_b16 v[80:81], v200 offset:16384
    ds_read_b64_tr_b16 v[82:83], v200 offset:16896
    ds_read_b64_tr_b16 v[84:85], v200 offset:20480
    ds_read_b64_tr_b16 v[86:87], v200 offset:20992
    s_waitcnt lgkmcnt(10)
    v_mfma_f32_16x16x32_bf16 v[32:35], v[64:67], v[128:131], 0
    ds_read_b64_tr_b16 v[64:65], v200 offset:24576
    ds_read_b64_tr_b16 v[66:67], v200 offset:25088
    s_waitcnt lgkmcnt(10)
    v_mfma_f32_16x16x32_bf16 v[32:35], v[68:71], v[132:135], v[32:35]
    ds_read_b64_tr_b16 v[68:69], v200 offset:28672
    ds_read_b64_tr_b16 v[70:71], v200 offset:29184
    s_waitcnt lgkmcnt(10)
    v_mfma_f32_16x16x32_bf16 v[32:35], v[72:75], v[136:139], v[32:35]
    ds_read_b64_tr_b16 v[72:73], v200 offset:32768
    ds_read_b64_tr_b16 v[74:75], v200 offset:33280
    s_waitcnt lgkmcnt(10)
    v_mfma_f32_16x16x32_bf16 v[32:35], v[76:79], v[140:143], v[32:35]
    ds_read_b64_tr_b16 v[76:77], v200 offset:36864
    ds_read_b64_tr_b16 v[78:79], v200 offset:37376
    s_waitcnt lgkmcnt(10)
    v_mfma_f32_16x16x32_bf16 v[32:35], v[80:83], v[144:147], v[32:35]
    ds_read_b64_tr_b16 v[80:81], v200 offset:40960
    ds_read_b64_tr_b16 v[82:83], v200 offset:41472
    s_waitcnt lgkmcnt(10)
    v_mfma_f32_16x16x32_bf16 v[32:35], v[84:87], v[148:151], v[32:35]
    ds_read_b64_tr_b16 v[84:85], v200 offset:45056
    ds_read_b64_tr_b16 v[86:87], v200 offset:45568
    s_waitcnt lgkmcnt(10)
    v_mfma_f32_16x16x32_bf16 v[32:35], v[64:67], v[152:155], v[32:35]
    ds_read_b64_tr_b16 v[64:65], v200 offset:49152
    ds_read_b64_tr_b16 v[66:67], v200 offset:49664
    s_waitcnt lgkmcnt(10)
    v_mfma_f32_16x16x32_bf16 v[32:35], v[68:71], v[156:159], v[32:35]
    ds_read_b64_tr_b16 v[68:69], v200 offset:53248
    ds_read_b64_tr_b16 v[70:71], v200 offset:53760
    s_waitcnt lgkmcnt(10)
    v_mfma_f32_16x16x32_bf16 v[32:35], v[72:75], v[160:163], v[32:35]
    ds_read_b64_tr_b16 v[72:73], v200 offset:57344
    ds_read_b64_tr_b16 v[74:75], v200 offset:57856
    s_waitcnt lgkmcnt(10)
    v_mfma_f32_16x16x32_bf16 v[32:35], v[76:79], v[164:167], v[32:35]
    ds_read_b64_tr_b16 v[76:77], v200 offset:61440
    ds_read_b64_tr_b16 v[78:79], v200 offset:61952
    s_waitcnt lgkmcnt(10)
    v_mfma_f32_16x16x32_bf16 v[32:35], v[80:83], v[168:171], v[32:35]
    s_waitcnt lgkmcnt(8)
    v_mfma_f32_16x16x32_bf16 v[32:35], v[84:87], v[172:175], v[32:35]
    s_waitcnt lgkmcnt(6)
    v_mfma_f32_16x16x32_bf16 v[32:35], v[64:67], v[176:179], v[32:35]
    s_waitcnt lgkmcnt(4)
    v_mfma_f32_16x16x32_bf16 v[32:35], v[68:71], v[180:183], v[32:35]
    s_waitcnt lgkmcnt(2)
    v_mfma_f32_16x16x32_bf16 v[32:35], v[72:75], v[184:187], v[32:35]
    s_waitcnt lgkmcnt(0)
    v_mfma_f32_16x16x32_bf16 v[32:35], v[76:79], v[188:191], v[32:35]
    s_nop 7
    v_cvt_pk_bf16_f32 v36, v32, v33
    v_cvt_pk_bf16_f32 v38, v34, v35
    s_mov_b64 exec, s[62:63]
    global_store_dwordx4 v206, v[36:39], s[10:11] sc1
    s_mov_b64 exec, -1
L_moda_b:
    s_cmp_lt_u32 s66, 12
    s_cbranch_scc0 L_FIN_A
    s_barrier
    s_add_u32 s46, s67, 65536
    s_mov_b32 m0, s46
    s_nop 0
    global_load_lds_dwordx4 v22, s[12:13] nt
    s_add_u32 m0, s46, 1024
    v_add_u32 v23, 49152, v23
    global_load_lds_dwordx4 v23, s[12:13] nt
    s_add_u32 m0, s46, 2048
    v_add_u32 v22, 98304, v22
    global_load_lds_dwordx4 v22, s[12:13] nt
    s_add_u32 m0, s46, 3072
    v_add_u32 v23, 98304, v23
    global_load_lds_dwordx4 v23, s[12:13] nt
    s_add_u32 m0, s46, 4096
    v_add_u32 v22, 98304, v22
    global_load_lds_dwordx4 v22, s[12:13] nt
    s_add_u32 m0, s46, 5120
    v_add_u32 v23, 98304, v23
    global_load_lds_dwordx4 v23, s[12:13] nt
    s_add_u32 m0, s46, 6144
    v_add_u32 v22, 98304, v22
    global_load_lds_dwordx4 v22, s[12:13] nt
    s_add_u32 m0, s46, 7168
    v_add_u32 v23, 98304, v23
    global_load_lds_dwordx4 v23, s[12:13] nt
    s_waitcnt vmcnt(0)
    s_barrier
    s_cmp_lt_u32 s3, 4
    s_cbranch_scc0 L_moda_c
    ds_read_b64_tr_b16 v[64:65], v201 offset:0
    ds_read_b64_tr_b16 v[66:67], v201 offset:512
    ds_read_b64_tr_b16 v[68:69], v201 offset:4096
    ds_read_b64_tr_b16 v[70:71], v201 offset:4608
    ds_read_b64_tr_b16 v[72:73], v201 offset:8192
    ds_read_b64_tr_b16 v[74:75], v201 offset:8704
    ds_read_b64_tr_b16 v[76:77], v201 offset:12288
    ds_read_b64_tr_b16 v[78:79], v201 offset:12800
    ds_read_b64_tr_b16 v[80:81], v201 offset:16384
    ds_read_b64_tr_b16 v[82:83], v201 offset:16896
    ds_read_b64_tr_b16 v[84:85], v201 offset:20480
    ds_read_b64_tr_b16 v[86:87], v201 offset:20992
    s_waitcnt lgkmcnt(10)
    v_mfma_f32_16x16x32_bf16 v[32:35], v[64:67], v[128:131], 0
    ds_read_b64_tr_b16 v[64:65], v201 offset:24576
    ds_read_b64_tr_b16 v[66:67], v201 offset:25088
    s_waitcnt lgkmcnt(10)
    v_mfma_f32_16x16x32_bf16 v[32:35], v[68:71], v[132:135], v[32:35]
    ds_read_b64_tr_b16 v[68:69], v201 offset:28672
    ds_read_b64_tr_b16 v[70:71], v201 offset:29184
    s_waitcnt lgkmcnt(10)
    v_mfma_f32_16x16x32_bf16 v[32:35], v[72:75], v[136:139], v[32:35]
    ds_read_b64_tr_b16 v[72:73], v201 offset:32768
    ds_read_b64_tr_b16 v[74:75], v201 offset:33280
    s_waitcnt lgkmcnt(10)
    v_mfma_f32_16x16x32_bf16 v[32:35], v[76:79], v[140:143], v[32:35]
    ds_read_b64_tr_b16 v[76:77], v201 offset:36864
    ds_read_b64_tr_b16 v[78:79], v201 offset:37376
    s_waitcnt lgkmcnt(10)
    v_mfma_f32_16x16x32_bf16 v[32:35], v[80:83], v[144:147], v[32:35]
    ds_read_b64_tr_b16 v[80:81], v201 offset:40960
    ds_read_b64_tr_b16 v[82:83], v201 offset:41472
    s_waitcnt lgkmcnt(10)
    v_mfma_f32_16x16x32_bf16 v[32:35], v[84:87], v[148:151], v[32:35]
    ds_read_b64_tr_b16 v[84:85], v201 offset:45056
    ds_read_b64_tr_b16 v[86:87], v201 offset:45568
    s_waitcnt lgkmcnt(10)
    v_mfma_f32_16x16x32_bf16 v[32:35], v[64:67], v[152:155], v[32:35]
    ds_read_b64_tr_b16 v[64:65], v201 offset:49152
    ds_read_b64_tr_b16 v[66:67], v201 offset:49664
    s_waitcnt lgkmcnt(10)
    v_mfma_f32_16x16x32_bf16 v[32:35], v[68:71], v[156:159], v[32:35]
    ds_read_b64_tr_b16 v[68:69], v201 offset:53248
    ds_read_b64_tr_b16 v[70:71], v201 offset:53760
    s_waitcnt lgkmcnt(10)
    v_mfma_f32_16x16x32_bf16 v[32:35], v[72:75], v[160:163], v[32:35]
    ds_read_b64_tr_b16 v[72:73], v201 offset:57344
    ds_read_b64_tr_b16 v[74:75], v201 offset:57856
    s_waitcnt lgkmcnt(10)
    v_mfma_f32_16x16x32_bf16 v[32:35], v[76:79], v[164:167], v[32:35]
    ds_read_b64_tr_b16 v[76:77], v201 offset:61440
    ds_read_b64_tr_b16 v[78:79], v201 offset:61952
    s_waitcnt lgkmcnt(10)
    v_mfma_f32_16x16x32_bf16 v[32:35], v[80:83], v[168:171], v[32:35]
    s_waitcnt lgkmcnt(8)
    v_mfma_f32_16x16x32_bf16 v[32:35], v[84:87], v[172:175], v[32:35]
    s_waitcnt lgkmcnt(6)
    v_mfma_f32_16x16x32_bf16 v[32:35], v[64:67], v[176:179], v[32:35]
    s_waitcnt lgkmcnt(4)
    v_mfma_f32_16x16x32_bf16 v[32:35], v[68:71], v[180:183], v[32:35]
    s_waitcnt lgkmcnt(2)
    v_mfma_f32_16x16x32_bf16 v[32:35], v[72:75], v[184:187], v[32:35]
    s_waitcnt lgkmcnt(0)
    v_mfma_f32_16x16x32_bf16 v[32:35], v[76:79], v[188:191], v[32:35]
    s_nop 7
    v_cvt_pk_bf16_f32 v36, v32, v33
    v_cvt_pk_bf16_f32 v38, v34, v35
    s_mov_b64 exec, s[62:63]
    global_store_dwordx4 v206, v[36:39], s[14:15] sc1
    s_mov_b64 exec, -1
L_moda_c:
L_FIN_A:
    s_branch L_FIN
L_QP:
    s_sub_u32 s45, s5, 16
    v_lshrrev_b32 v5, 3, v1
    s_mov_b32 s57, 8192
    v_mul_lo_u32 v20, s57, v5
    v_bfe_u32 v5, v1, 1, 2
    v_bfe_u32 v6, v1, 4, 1
    v_xor_b32 v5, v5, v6
    v_lshl_add_u32 v20, v5, 5, v20
    v_and_b32 v5, 1, v1
    v_lshl_add_u32 v20, v5, 4, v20
    v_xor_b32 v21, 64, v20
    s_lshl_b32 s46, s3, 19
    s_lshl_b32 s47, s4, 10
    s_add_u32 s46, s46, s47
    s_lshl_b32 s47, s45, 7
    s_add_u32 s46, s46, s47
    s_lshl_b32 s67, s3, 13
    s_add_u32 s67, s67, 17408
    v_bfe_u32 v2, v0, 2, 2
    v_lshrrev_b32 v3, 4, v0
    v_lshlrev_b32 v3, 5, v3
    v_and_b32 v254, 3, v0
    v_lshl_add_u32 v3, v254, 3, v3
    v_lshl_add_u32 v4, v2, 10, v3
    s_waitcnt lgkmcnt(0)
    s_load_dword s7, s[42:43], 0
    s_add_u32 s8, s22, s46
    s_addc_u32 s9, s23, 0
    global_load_dwordx2 v[6:7], v4, s[16:17]
    s_mov_b32 m0, s67
    s_nop 0
    global_load_lds_dwordx4 v20, s[8:9] nt
    s_add_u32 m0, s67, 1024
    v_add_u32 v21, 65536, v21
    global_load_lds_dwordx4 v21, s[8:9] nt
    s_add_u32 m0, s67, 2048
    v_add_u32 v20, 131072, v20
    global_load_lds_dwordx4 v20, s[8:9] nt
    s_add_u32 m0, s67, 3072
    v_add_u32 v21, 131072, v21
    global_load_lds_dwordx4 v21, s[8:9] nt
    s_add_u32 m0, s67, 4096
    v_add_u32 v20, 131072, v20
    global_load_lds_dwordx4 v20, s[8:9] nt
    s_add_u32 m0, s67, 5120
    v_add_u32 v21, 131072, v21
    global_load_lds_dwordx4 v21, s[8:9] nt
    s_add_u32 m0, s67, 6144
    v_add_u32 v20, 131072, v20
    global_load_lds_dwordx4 v20, s[8:9] nt
    s_add_u32 m0, s67, 7168
    v_add_u32 v21, 131072, v21
    global_load_lds_dwordx4 v21, s[8:9] nt
    s_lshl_b32 s58, s4, 19
    v_min_u32 v227, 7, v1
    v_lshlrev_b32 v227, 16, v227
    v_add_u32 v227, s58, v227
    global_load_dword v246, v227, s[24:25]
    s_mov_b32 s53, 0x3fb8aa3b
    s_mov_b32 s54, 0xbfb8aa3b
    s_mov_b32 s55, 0x3db504f3
    s_mov_b32 s68, 0x00003f80
    s_mov_b32 s69, 0x3f800000
    v_lshrrev_b32 v8, 4, v1
    v_bfe_u32 v9, v1, 2, 2
    v_lshl_add_u32 v200, v8, 3, v9
    v_lshlrev_b32 v200, 7, v200
    v_and_b32 v8, 1, v8
    v_lshrrev_b32 v9, 1, v9
    v_lshl_add_u32 v8, v8, 1, v9
    s_and_b32 s57, s3, 3
    v_xor_b32 v8, s57, v8
    v_lshl_add_u32 v200, v8, 5, v200
    v_bfe_u32 v8, v1, 1, 1
    v_lshl_add_u32 v200, v8, 4, v200
    v_and_b32 v8, 1, v1
    v_lshl_add_u32 v200, v8, 3, v200
    v_add_u32 v200, 17408, v200
    v_and_b32 v8, 3, v1
    v_mul_u32_u24 v204, 1088, v8
    v_lshrrev_b32 v8, 4, v1
    v_lshl_add_u32 v204, v8, 4, v204
    v_mul_u32_u24 v207, 1088, v2
    v_add_u32 v207, v207, v3
    v_lshlrev_b32 v208, 4, v0
    v_lshlrev_b32 v11, 6, v2
    v_add_u32 v11, 8704, v11
    s_lshl_b32 s57, s3, 3
    v_add_u32 v10, s57, v11
    s_add_u32 s10, s42, 0x3000
    s_addc_u32 s11, s43, 0
    s_waitcnt vmcnt(9)
    v_lshlrev_b32 v32, 16, v6
    v_and_b32 v33, s52, v6
    v_lshlrev_b32 v34, 16, v7
    v_and_b32 v35, s52, v7
    v_add_f32 v36, v32, v33
    v_mul_f32 v37, v32, v32
    v_add_f32 v38, v34, v35
    v_fmac_f32 v37, v33, v33
    v_add_f32 v36, v36, v38
    v_fmac_f32 v37, v34, v34
    v_fmac_f32 v37, v35, v35
    v_add_f32_dpp v36, v36, v36 quad_perm:[1,0,3,2] row_mask:0xf bank_mask:0xf
    s_nop 0
    v_add_f32_dpp v37, v37, v37 quad_perm:[1,0,3,2] row_mask:0xf bank_mask:0xf
    v_add_f32_dpp v36, v36, v36 quad_perm:[2,3,0,1] row_mask:0xf bank_mask:0xf
    s_nop 0
    v_add_f32_dpp v37, v37, v37 quad_perm:[2,3,0,1] row_mask:0xf bank_mask:0xf
    v_mov_b32 v38, v36
    v_mov_b32 v39, v37
    s_nop 0
    v_permlane16_swap_b32 v36, v38
    v_permlane16_swap_b32 v37, v39
    v_add_f32 v36, v36, v38
    v_add_f32 v37, v37, v39
    v_mov_b32 v38, v36
    v_mov_b32 v39, v37
    s_nop 0
    v_permlane32_swap_b32 v36, v38
    v_permlane32_swap_b32 v37, v39
    v_add_f32 v36, v36, v38
    v_add_f32 v37, v37, v39
    s_mov_b64 exec, 0x1111
    ds_write_b64 v10, v[36:37]
    s_mov_b64 exec, -1
    s_waitcnt lgkmcnt(0)
    s_mul_i32 s6, s7, 1664525
    s_add_u32 s6, s6, 1013904223
    s_add_u32 s46, s45, 16
    s_getreg_b32 s86, hwreg(HW_REG_XCC_ID, 0, 4)
    s_cmp_eq_u32 s3, 0
    s_cbranch_scc0 L_xcp_1
    s_lshl_b32 s57, s4, 8
    s_lshl_b32 s58, s46, 3
    s_add_u32 s57, s57, s58
    s_add_u32 s57, s57, 4096
    v_mov_b32 v250, s57
    v_mov_b32 v252, s86
    v_mov_b32 v253, s6
    s_mov_b64 exec, 1
    global_store_dwordx2 v250, v[252:253], s[42:43] sc1
    s_mov_b64 exec, -1
L_xcp_1:
    s_barrier
    ds_read_b128 v[40:43], v11 offset:0
    ds_read_b128 v[44:47], v11 offset:16
    ds_read_b128 v[48:51], v11 offset:32
    ds_read_b128 v[52:55], v11 offset:48
    s_waitcnt lgkmcnt(0)
    v_pk_add_f32 v[40:41], v[40:41], v[42:43]
    v_pk_add_f32 v[44:45], v[44:45], v[46:47]
    v_pk_add_f32 v[48:49], v[48:49], v[50:51]
    v_pk_add_f32 v[52:53], v[52:53], v[54:55]
    v_pk_add_f32 v[40:41], v[40:41], v[44:45]
    v_pk_add_f32 v[48:49], v[48:49], v[52:53]
    v_pk_add_f32 v[40:41], v[40:41], v[48:49]
    v_mul_f32 v60, 0x3b000000, v40
    v_mul_f32 v41, 0x3b000000, v41
    v_fma_f32 v41, -v60, v60, v41
    v_max_f32 v41, 0, v41
    v_cvt_pk_bf16_f32 v40, v60, v41
    v_lshlrev_b32 v60, 16, v40
    v_and_b32 v41, s52, v40
    v_add_f32 v41, 0x3727c5ac, v41
    v_cvt_pk_bf16_f32 v40, v41, v41
    v_and_b32 v41, s52, v40
    v_sqrt_f32 v41, v41
    s_nop 0
    v_cvt_pk_bf16_f32 v40, v41, v41
    v_and_b32 v41, s52, v40
    v_rcp_f32 v61, v41
    v_sub_f32 v32, v32, v60
    v_sub_f32 v33, v33, v60
    v_sub_f32 v34, v34, v60
    v_sub_f32 v35, v35, v60
    v_cvt_pk_bf16_f32 v28, v32, v33
    v_cvt_pk_bf16_f32 v29, v34, v35
    v_lshlrev_b32 v32, 16, v28
    v_and_b32 v33, s52, v28
    v_lshlrev_b32 v34, 16, v29
    v_and_b32 v35, s52, v29
    v_mul_f32 v32, v32, v61
    v_mul_f32 v33, v33, v61
    v_mul_f32 v34, v34, v61
    v_mul_f32 v35, v35, v61
    v_cvt_pk_bf16_f32 v28, v32, v33
    v_cvt_pk_bf16_f32 v29, v34, v35
    v_lshlrev_b32 v32, 16, v28
    v_and_b32 v33, s52, v28
    v_lshlrev_b32 v34, 16, v29
    v_and_b32 v35, s52, v29
    v_lshrrev_b32 v4, 3, v1
    s_mov_b32 s57, 1024
    v_mul_lo_u32 v22, s57, v4
    v_bfe_u32 v4, v1, 1, 2
    v_bfe_u32 v5, v1, 4, 1
    v_xor_b32 v4, v4, v5
    v_lshl_add_u32 v22, v4, 5, v22
    v_and_b32 v4, 1, v1
    v_lshl_add_u32 v22, v4, 4, v22
    v_xor_b32 v23, 64, v22
    s_lshl_b32 s46, s4, 19
    s_lshl_b32 s47, s3, 16
    s_add_u32 s46, s46, s47
    s_lshl_b32 s47, s45, 7
    s_add_u32 s46, s46, s47
    s_add_u32 s12, s24, s46
    s_addc_u32 s13, s25, 0
    v_and_b32 v4, 3, v1
    v_lshlrev_b32 v206, 6, v4
    v_lshrrev_b32 v4, 4, v1
    v_lshl_add_u32 v206, v4, 4, v206
    s_and_b32 s57, s3, 3
    s_lshl_b32 s57, s57, 8
    v_add_u32 v206, s57, v206
    s_lshl_b32 s46, s4, 13
    s_lshl_b32 s47, s45, 10
    s_add_u32 s46, s46, s47
    s_add_u32 s46, s46, 65536
    s_add_u32 s14, s42, s46
    s_addc_u32 s15, s43, 0
    v_mov_b32 v49, s6
    v_mov_b32 v51, s6
    v_add_u32 v209, 4096, v208
    s_waitcnt vmcnt(0)
    s_barrier
    s_cmp_lt_u32 s3, 4
    s_cbranch_scc0 L_qp_a
    ds_read_b64_tr_b16 v[128:129], v200 offset:0
    ds_read_b64_tr_b16 v[130:131], v200 offset:512
    ds_read_b64_tr_b16 v[132:133], v200 offset:4096
    ds_read_b64_tr_b16 v[134:135], v200 offset:4608
    ds_read_b64_tr_b16 v[136:137], v200 offset:8192
    ds_read_b64_tr_b16 v[138:139], v200 offset:8704
    ds_read_b64_tr_b16 v[140:141], v200 offset:12288
    ds_read_b64_tr_b16 v[142:143], v200 offset:12800
    ds_read_b64_tr_b16 v[144:145], v200 offset:16384
    ds_read_b64_tr_b16 v[146:147], v200 offset:16896
    ds_read_b64_tr_b16 v[148:149], v200 offset:20480
    ds_read_b64_tr_b16 v[150:151], v200 offset:20992
    s_waitcnt lgkmcnt(8)
    ds_read_b64_tr_b16 v[152:153], v200 offset:24576
    ds_read_b64_tr_b16 v[154:155], v200 offset:25088
    ds_read_b64_tr_b16 v[156:157], v200 offset:28672
    ds_read_b64_tr_b16 v[158:159], v200 offset:29184
    s_waitcnt lgkmcnt(8)
    ds_read_b64_tr_b16 v[160:161], v200 offset:32768
    ds_read_b64_tr_b16 v[162:163], v200 offset:33280
    ds_read_b64_tr_b16 v[164:165], v200 offset:36864
    ds_read_b64_tr_b16 v[166:167], v200 offset:37376
    s_waitcnt lgkmcnt(8)
    ds_read_b64_tr_b16 v[168:169], v200 offset:40960
    ds_read_b64_tr_b16 v[170:171], v200 offset:41472
    ds_read_b64_tr_b16 v[172:173], v200 offset:45056
    ds_read_b64_tr_b16 v[174:175], v200 offset:45568
    s_waitcnt lgkmcnt(8)
    ds_read_b64_tr_b16 v[176:177], v200 offset:49152
    ds_read_b64_tr_b16 v[178:179], v200 offset:49664
    ds_read_b64_tr_b16 v[180:181], v200 offset:53248
    ds_read_b64_tr_b16 v[182:183], v200 offset:53760
    s_waitcnt lgkmcnt(8)
    ds_read_b64_tr_b16 v[184:185], v200 offset:57344
    ds_read_b64_tr_b16 v[186:187], v200 offset:57856
    ds_read_b64_tr_b16 v[188:189], v200 offset:61440
    ds_read_b64_tr_b16 v[190:191], v200 offset:61952
L_qp_a:
    global_load_dwordx4 v[8:11], v208, s[10:11] offset:-4096 sc1
    global_load_dwordx4 v[12:15], v209, s[10:11] sc1
L_tchk_2:
    s_waitcnt vmcnt(0)
    v_cmp_ne_u32 s[88:89], s6, v9
    v_cmp_ne_u32 s[90:91], s6, v13
    s_or_b64 s[60:61], s[88:89], s[90:91]
    s_cmp_lg_u64 s[60:61], 0
    s_cbranch_scc1 L_tretry_3
    v_lshlrev_b32 v40, 16, v12
    v_and_b32 v41, s52, v12
    v_lshlrev_b32 v42, 16, v14
    v_and_b32 v43, s52, v14
    v_add_f32 v40, 1.0, v40
    v_add_f32 v41, 1.0, v41
    v_add_f32 v42, 1.0, v42
    v_add_f32 v43, 1.0, v43
    v_cvt_pk_bf16_f32 v28, v40, v41
    v_cvt_pk_bf16_f32 v29, v42, v43
    v_lshlrev_b32 v40, 16, v28
    v_and_b32 v41, s52, v28
    v_lshlrev_b32 v42, 16, v29
    v_and_b32 v43, s52, v29
    v_lshlrev_b32 v36, 16, v8
    v_and_b32 v37, s52, v8
    v_lshlrev_b32 v38, 16, v10
    v_and_b32 v39, s52, v10
    v_mul_f32 v32, v32, v40
    v_mul_f32 v33, v33, v41
    v_mul_f32 v34, v34, v42
    v_mul_f32 v35, v35, v43
    v_cvt_pk_bf16_f32 v28, v32, v33
    v_cvt_pk_bf16_f32 v29, v34, v35
    v_lshlrev_b32 v32, 16, v28
    v_and_b32 v33, s52, v28
    v_lshlrev_b32 v34, 16, v29
    v_and_b32 v35, s52, v29
    v_add_f32 v32, v32, v36
    v_add_f32 v33, v33, v37
    v_add_f32 v34, v34, v38
    v_add_f32 v35, v35, v39
    v_cvt_pk_bf16_f32 v28, v32, v33
    v_cvt_pk_bf16_f32 v29, v34, v35
    ds_write_b64 v207, v[28:29] offset:0
    s_waitcnt lgkmcnt(0)
    s_barrier
    s_cmp_lt_u32 s3, 4
    s_cbranch_scc0 L_qp_b
    ds_read_b128 v[64:67], v204 offset:0
    ds_read_b128 v[68:71], v204 offset:64
    ds_read_b128 v[72:75], v204 offset:128
    ds_read_b128 v[76:79], v204 offset:192
    ds_read_b128 v[80:83], v204 offset:256
    ds_read_b128 v[84:87], v204 offset:320
    ds_read_b128 v[88:91], v204 offset:384
    ds_read_b128 v[92:95], v204 offset:448
    s_waitcnt lgkmcnt(7)
    v_mfma_f32_16x16x32_bf16 v[32:35], v[128:131], v[64:67], 0
    ds_read_b128 v[64:67], v204 offset:512
    s_waitcnt lgkmcnt(7)
    v_mfma_f32_16x16x32_bf16 v[32:35], v[132:135], v[68:71], v[32:35]
    ds_read_b128 v[68:71], v204 offset:576
    s_waitcnt lgkmcnt(7)
    v_mfma_f32_16x16x32_bf16 v[32:35], v[136:139], v[72:75], v[32:35]
    ds_read_b128 v[72:75], v204 offset:640
    s_waitcnt lgkmcnt(7)
    v_mfma_f32_16x16x32_bf16 v[32:35], v[140:143], v[76:79], v[32:35]
    ds_read_b128 v[76:79], v204 offset:704
    s_waitcnt lgkmcnt(7)
    v_mfma_f32_16x16x32_bf16 v[32:35], v[144:147], v[80:83], v[32:35]
    ds_read_b128 v[80:83], v204 offset:768
    s_waitcnt lgkmcnt(7)
    v_mfma_f32_16x16x32_bf16 v[32:35], v[148:151], v[84:87], v[32:35]
    ds_read_b128 v[84:87], v204 offset:832
    s_waitcnt lgkmcnt(7)
    v_mfma_f32_16x16x32_bf16 v[32:35], v[152:155], v[88:91], v[32:35]
    ds_read_b128 v[88:91], v204 offset:896
    s_waitcnt lgkmcnt(7)
    v_mfma_f32_16x16x32_bf16 v[32:35], v[156:159], v[92:95], v[32:35]
    ds_read_b128 v[92:95], v204 offset:960
    s_waitcnt lgkmcnt(7)
    v_mfma_f32_16x16x32_bf16 v[32:35], v[160:163], v[64:67], v[32:35]
    s_waitcnt lgkmcnt(6)
    v_mfma_f32_16x16x32_bf16 v[32:35], v[164:167], v[68:71], v[32:35]
    s_waitcnt lgkmcnt(5)
    v_mfma_f32_16x16x32_bf16 v[32:35], v[168:171], v[72:75], v[32:35]
    s_waitcnt lgkmcnt(4)
    v_mfma_f32_16x16x32_bf16 v[32:35], v[172:175], v[76:79], v[32:35]
    s_waitcnt lgkmcnt(3)
    v_mfma_f32_16x16x32_bf16 v[32:35], v[176:179], v[80:83], v[32:35]
    s_waitcnt lgkmcnt(2)
    v_mfma_f32_16x16x32_bf16 v[32:35], v[180:183], v[84:87], v[32:35]
    s_waitcnt lgkmcnt(1)
    v_mfma_f32_16x16x32_bf16 v[32:35], v[184:187], v[88:91], v[32:35]
    s_waitcnt lgkmcnt(0)
    v_mfma_f32_16x16x32_bf16 v[32:35], v[188:191], v[92:95], v[32:35]
    s_nop 7
    v_cvt_pk_bf16_f32 v48, v32, v33
    v_cvt_pk_bf16_f32 v50, v34, v35
    s_mov_b64 exec, s[62:63]
    global_store_dwordx4 v206, v[48:51], s[14:15] sc1
    s_mov_b64 exec, -1
L_qp_b:
    s_barrier
    s_add_u32 s46, s67, 65536
    s_mov_b32 m0, s46
    s_nop 0
    global_load_lds_dwordx4 v22, s[12:13] nt
    s_add_u32 m0, s46, 1024
    v_add_u32 v23, 8192, v23
    global_load_lds_dwordx4 v23, s[12:13] nt
    s_add_u32 m0, s46, 2048
    v_add_u32 v22, 16384, v22
    global_load_lds_dwordx4 v22, s[12:13] nt
    s_add_u32 m0, s46, 3072
    v_add_u32 v23, 16384, v23
    global_load_lds_dwordx4 v23, s[12:13] nt
    s_add_u32 m0, s46, 4096
    v_add_u32 v22, 16384, v22
    global_load_lds_dwordx4 v22, s[12:13] nt
    s_add_u32 m0, s46, 5120
    v_add_u32 v23, 16384, v23
    global_load_lds_dwordx4 v23, s[12:13] nt
    s_add_u32 m0, s46, 6144
    v_add_u32 v22, 16384, v22
    global_load_lds_dwordx4 v22, s[12:13] nt
    s_add_u32 m0, s46, 7168
    v_add_u32 v23, 16384, v23
    global_load_lds_dwordx4 v23, s[12:13] nt
    v_lshrrev_b32 v2, 7, v0
    v_and_b32 v3, 127, v0
    v_lshlrev_b32 v5, 12, v2
    v_lshl_add_u32 v5, v3, 3, v5
    s_lshl_b32 s46, s4, 14
    s_add_u32 s46, s46, 131072
    s_add_u32 s8, s42, s46
    s_addc_u32 s9, s43, 0
    v_bfe_u32 v4, v0, 2, 2
    v_lshlrev_b32 v6, 9, v2
    v_lshl_add_u32 v6, v4, 2, v6
    s_lshl_b32 s46, s4, 11
    s_add_u32 s46, s46, 262144
    s_add_u32 s10, s42, s46
    s_addc_u32 s11, s43, 0
    v_mul_u32_u24 v7, 1088, v2
    v_lshl_add_u32 v7, v4, 8, v7
    v_lshrrev_b32 v8, 4, v3
    v_lshl_add_u32 v7, v8, 5, v7
    v_and_b32 v8, 3, v0
    v_lshl_add_u32 v7, v8, 3, v7
    v_and_b32 v8, 3, v1
    v_lshlrev_b32 v206, 5, v8
    v_lshrrev_b32 v8, 4, v1
    v_lshl_add_u32 v206, v8, 3, v206
    s_and_b32 s57, s3, 3
    s_lshl_b32 s57, s57, 7
    v_add_u32 v206, s57, v206
    s_lshl_b32 s46, s4, 12
    s_lshl_b32 s47, s45, 9
    s_add_u32 s46, s46, s47
    s_add_u32 s46, s46, 278528
    s_add_u32 s14, s42, s46
    s_addc_u32 s15, s43, 0
    v_add_u32 v201, 65536, v200
    v_and_b32 v12, 15, v1
    v_lshlrev_b32 v12, 7, v12
    v_add_u32 v12, 6144, v12
L_poll_4:
    global_load_dwordx2 v[14:15], v12, s[42:43] sc1
    s_waitcnt vmcnt(0)
    v_cmp_eq_u32 vcc, s6, v15
    s_cmp_eq_u64 vcc, exec
    s_cbranch_scc0 L_retry_5
    s_barrier
    s_cmp_lt_u32 s3, 4
    s_cbranch_scc0 L_qp_c
    ds_read_b64_tr_b16 v[128:129], v201 offset:0
    ds_read_b64_tr_b16 v[130:131], v201 offset:512
    ds_read_b64_tr_b16 v[132:133], v201 offset:4096
    ds_read_b64_tr_b16 v[134:135], v201 offset:4608
    ds_read_b64_tr_b16 v[136:137], v201 offset:8192
    ds_read_b64_tr_b16 v[138:139], v201 offset:8704
    ds_read_b64_tr_b16 v[140:141], v201 offset:12288
    ds_read_b64_tr_b16 v[142:143], v201 offset:12800
    ds_read_b64_tr_b16 v[144:145], v201 offset:16384
    ds_read_b64_tr_b16 v[146:147], v201 offset:16896
    ds_read_b64_tr_b16 v[148:149], v201 offset:20480
    ds_read_b64_tr_b16 v[150:151], v201 offset:20992
    s_waitcnt lgkmcnt(8)
    ds_read_b64_tr_b16 v[152:153], v201 offset:24576
    ds_read_b64_tr_b16 v[154:155], v201 offset:25088
    ds_read_b64_tr_b16 v[156:157], v201 offset:28672
    ds_read_b64_tr_b16 v[158:159], v201 offset:29184
    s_waitcnt lgkmcnt(8)
    ds_read_b64_tr_b16 v[160:161], v201 offset:32768
    ds_read_b64_tr_b16 v[162:163], v201 offset:33280
    ds_read_b64_tr_b16 v[164:165], v201 offset:36864
    ds_read_b64_tr_b16 v[166:167], v201 offset:37376
    s_waitcnt lgkmcnt(8)
    ds_read_b64_tr_b16 v[168:169], v201 offset:40960
    ds_read_b64_tr_b16 v[170:171], v201 offset:41472
    ds_read_b64_tr_b16 v[172:173], v201 offset:45056
    ds_read_b64_tr_b16 v[174:175], v201 offset:45568
    s_waitcnt lgkmcnt(8)
    ds_read_b64_tr_b16 v[176:177], v201 offset:49152
    ds_read_b64_tr_b16 v[178:179], v201 offset:49664
    ds_read_b64_tr_b16 v[180:181], v201 offset:53248
    ds_read_b64_tr_b16 v[182:183], v201 offset:53760
    s_waitcnt lgkmcnt(8)
    ds_read_b64_tr_b16 v[184:185], v201 offset:57344
    ds_read_b64_tr_b16 v[186:187], v201 offset:57856
    ds_read_b64_tr_b16 v[188:189], v201 offset:61440
    ds_read_b64_tr_b16 v[190:191], v201 offset:61952
L_qp_c:
    global_load_dwordx2 v[64:65], v5, s[8:9] offset:0 sc1
    global_load_dwordx2 v[66:67], v5, s[8:9] offset:1024 sc1
    global_load_dwordx2 v[68:69], v5, s[8:9] offset:2048 sc1
    global_load_dwordx2 v[70:71], v5, s[8:9] offset:3072 sc1
    global_load_dword v80, v6, s[10:11] offset:0 sc1
    global_load_dword v81, v6, s[10:11] offset:128 sc1
    global_load_dword v82, v6, s[10:11] offset:256 sc1
    global_load_dword v83, v6, s[10:11] offset:384 sc1
L_schk_6:
    s_waitcnt vmcnt(0)
    v_max_u32 v254, v64, v65
    v_cmp_eq_u32 s[88:89], -1, v254
    v_max_u32 v254, v66, v67
    v_cmp_eq_u32 s[90:91], -1, v254
    s_or_b64 s[60:61], s[88:89], s[90:91]
    v_max_u32 v254, v68, v69
    v_cmp_eq_u32 s[92:93], -1, v254
    s_or_b64 s[60:61], s[60:61], s[92:93]
    v_max_u32 v254, v70, v71
    v_cmp_eq_u32 s[94:95], -1, v254
    s_or_b64 s[60:61], s[60:61], s[94:95]
    v_cmp_eq_u32 s[96:97], -1, v80
    s_or_b64 s[60:61], s[60:61], s[96:97]
    v_cmp_eq_u32 s[98:99], -1, v81
    s_or_b64 s[60:61], s[60:61], s[98:99]
    v_cmp_eq_u32 s[26:27], -1, v82
    s_or_b64 s[60:61], s[60:61], s[26:27]
    v_cmp_eq_u32 s[0:1], -1, v83
    s_or_b64 s[60:61], s[60:61], s[0:1]
    s_cmp_lg_u64 s[60:61], 0
    s_cbranch_scc1 L_sretry_7
    v_max3_f32 v24, v80, v81, v82
    v_max_f32 v24, v24, v83
    v_sub_f32 v28, v80, v24
    v_sub_f32 v29, v81, v24
    v_sub_f32 v30, v82, v24
    v_sub_f32 v31, v83, v24
    v_exp_f32 v28, v28
    v_exp_f32 v29, v29
    v_exp_f32 v30, v30
    v_exp_f32 v31, v31
    v_lshlrev_b32 v36, 16, v64
    v_and_b32 v37, s52, v64
    v_lshlrev_b32 v38, 16, v65
    v_and_b32 v39, s52, v65
    v_add_f32 v25, v28, v29
    v_add_f32 v26, v30, v31
    v_add_f32 v25, v25, v26
    v_rcp_f32 v25, v25
    v_mul_f32 v32, v36, v28
    v_mul_f32 v33, v37, v28
    v_mul_f32 v34, v38, v28
    v_mul_f32 v35, v39, v28
    v_lshlrev_b32 v36, 16, v66
    v_and_b32 v37, s52, v66
    v_lshlrev_b32 v38, 16, v67
    v_and_b32 v39, s52, v67
    v_fmac_f32 v32, v36, v29
    v_fmac_f32 v33, v37, v29
    v_fmac_f32 v34, v38, v29
    v_fmac_f32 v35, v39, v29
    v_lshlrev_b32 v36, 16, v68
    v_and_b32 v37, s52, v68
    v_lshlrev_b32 v38, 16, v69
    v_and_b32 v39, s52, v69
    v_fmac_f32 v32, v36, v30
    v_fmac_f32 v33, v37, v30
    v_fmac_f32 v34, v38, v30
    v_fmac_f32 v35, v39, v30
    v_lshlrev_b32 v36, 16, v70
    v_and_b32 v37, s52, v70
    v_lshlrev_b32 v38, 16, v71
    v_and_b32 v39, s52, v71
    v_fmac_f32 v32, v36, v31
    v_fmac_f32 v33, v37, v31
    v_fmac_f32 v34, v38, v31
    v_fmac_f32 v35, v39, v31
    v_mul_f32 v32, v32, v25
    v_mul_f32 v33, v33, v25
    v_mul_f32 v34, v34, v25
    v_mul_f32 v35, v35, v25
    v_cvt_pk_bf16_f32 v36, v32, v33
    v_cvt_pk_bf16_f32 v37, v34, v35
    ds_write_b64 v7, v[36:37] offset:4352
    s_waitcnt lgkmcnt(0)
    s_barrier
    s_cmp_lt_u32 s3, 4
    s_cbranch_scc0 L_FIN_QP
    ds_read_b128 v[64:67], v204 offset:4352
    ds_read_b128 v[68:71], v204 offset:4416
    ds_read_b128 v[72:75], v204 offset:4480
    ds_read_b128 v[76:79], v204 offset:4544
    ds_read_b128 v[80:83], v204 offset:4608
    ds_read_b128 v[84:87], v204 offset:4672
    ds_read_b128 v[88:91], v204 offset:4736
    ds_read_b128 v[92:95], v204 offset:4800
    s_waitcnt lgkmcnt(7)
    v_mfma_f32_16x16x32_bf16 v[32:35], v[128:131], v[64:67], 0
    ds_read_b128 v[64:67], v204 offset:4864
    s_waitcnt lgkmcnt(7)
    v_mfma_f32_16x16x32_bf16 v[32:35], v[132:135], v[68:71], v[32:35]
    ds_read_b128 v[68:71], v204 offset:4928
    s_waitcnt lgkmcnt(7)
    v_mfma_f32_16x16x32_bf16 v[32:35], v[136:139], v[72:75], v[32:35]
    ds_read_b128 v[72:75], v204 offset:4992
    s_waitcnt lgkmcnt(7)
    v_mfma_f32_16x16x32_bf16 v[32:35], v[140:143], v[76:79], v[32:35]
    ds_read_b128 v[76:79], v204 offset:5056
    s_waitcnt lgkmcnt(7)
    v_mfma_f32_16x16x32_bf16 v[32:35], v[144:147], v[80:83], v[32:35]
    ds_read_b128 v[80:83], v204 offset:5120
    s_waitcnt lgkmcnt(7)
    v_mfma_f32_16x16x32_bf16 v[32:35], v[148:151], v[84:87], v[32:35]
    ds_read_b128 v[84:87], v204 offset:5184
    s_waitcnt lgkmcnt(7)
    v_mfma_f32_16x16x32_bf16 v[32:35], v[152:155], v[88:91], v[32:35]
    ds_read_b128 v[88:91], v204 offset:5248
    s_waitcnt lgkmcnt(7)
    v_mfma_f32_16x16x32_bf16 v[32:35], v[156:159], v[92:95], v[32:35]
    ds_read_b128 v[92:95], v204 offset:5312
    s_waitcnt lgkmcnt(7)
    v_mfma_f32_16x16x32_bf16 v[32:35], v[160:163], v[64:67], v[32:35]
    s_waitcnt lgkmcnt(6)
    v_mfma_f32_16x16x32_bf16 v[32:35], v[164:167], v[68:71], v[32:35]
    s_waitcnt lgkmcnt(5)
    v_mfma_f32_16x16x32_bf16 v[32:35], v[168:171], v[72:75], v[32:35]
    s_waitcnt lgkmcnt(4)
    v_mfma_f32_16x16x32_bf16 v[32:35], v[172:175], v[76:79], v[32:35]
    s_waitcnt lgkmcnt(3)
    v_mfma_f32_16x16x32_bf16 v[32:35], v[176:179], v[80:83], v[32:35]
    s_waitcnt lgkmcnt(2)
    v_mfma_f32_16x16x32_bf16 v[32:35], v[180:183], v[84:87], v[32:35]
    s_waitcnt lgkmcnt(1)
    v_mfma_f32_16x16x32_bf16 v[32:35], v[184:187], v[88:91], v[32:35]
    s_waitcnt lgkmcnt(0)
    v_mfma_f32_16x16x32_bf16 v[32:35], v[188:191], v[92:95], v[32:35]
    s_nop 7
    v_cvt_pk_bf16_f32 v48, v32, v33
    v_cvt_pk_bf16_f32 v49, v34, v35
    v_min_u32 v48, -2, v48
    v_min_u32 v49, -2, v49
    s_mov_b64 exec, s[62:63]
    global_store_dwordx2 v206, v[48:49], s[14:15] sc1
    s_mov_b64 exec, -1
L_FIN_QP:
    s_branch L_FIN
L_ATT:
    s_lshr_b32 s44, s5, 2
    s_and_b32 s45, s5, 3
    s_lshl_b32 s46, s44, 3
    s_add_u32 s46, s46, s4
    s_lshl_b32 s46, s46, 20
    s_lshl_b32 s47, s45, 8
    s_lshl_b32 s57, s3, 5
    s_add_u32 s47, s47, s57
    s_add_u32 s47, s47, 3072
    s_lshl_b32 s47, s47, 8
    s_add_u32 s46, s46, s47
    v_and_b32 v2, 15, v1
    v_lshrrev_b32 v3, 4, v1
    v_xor_b32 v4, v2, v3
    v_lshlrev_b32 v4, 4, v4
    v_lshl_add_u32 v24, v3, 8, v4
    v_xor_b32 v25, 64, v24
    v_xor_b32 v26, 128, v24
    v_xor_b32 v27, 192, v24
    v_lshlrev_b32 v5, 1, v3
    v_xor_b32 v5, v5, v2
    v_lshlrev_b32 v5, 4, v5
    v_lshl_add_u32 v5, v3, 8, v5
    v_xor_b32 v6, 128, v5
    s_lshl_b32 s67, s3, 13
    s_add_u32 s47, s46, 4096
    s_mov_b32 s66, s46
    s_mov_b32 s59, s47
    s_waitcnt lgkmcnt(0)
    s_load_dword s7, s[42:43], 0
    s_lshl_b32 s46, s5, 3
    s_add_u32 s46, s46, s3
    v_lshrrev_b32 v8, 3, v1
    v_and_b32 v9, 7, v1
    v_lshlrev_b32 v9, 4, v9
    s_cmp_lt_u32 s46, 64
    s_cbranch_scc0 L_h_o
    s_and_b32 s47, s46, 31
    s_lshl_b32 s47, s47, 3
    s_add_u32 s47, s47, 256
    s_lshl_b32 s57, s4, 10
    s_add_u32 s57, s57, 384
    s_cmp_lt_u32 s46, 32
    s_cbranch_scc0 L_h_m
    v_add_u32 v10, s47, v8
    v_lshlrev_b32 v10, 13, v10
    v_add_u32 v10, v10, v9
    v_add_u32 v10, s57, v10
    global_load_dwordx4 v[240:243], v10, s[22:23] nt
    s_branch L_h_end
L_h_m:
    s_cmp_lt_u32 s4, 2
    s_cbranch_scc0 L_h_end
    v_add_u32 v10, s47, v8
    v_mul_u32_u24 v10, 6144, v10
    v_add_u32 v10, v10, v9
    v_add_u32 v10, s57, v10
    global_load_dwordx4 v[240:243], v10, s[36:37] nt
    s_branch L_h_end
L_h_o:
    s_and_b32 s47, s46, 63
    s_lshl_b32 s47, s47, 3
    s_lshl_b32 s57, s4, 9
    s_add_u32 s47, s47, s57
    s_movk_i32 s57, 384
    v_add_u32 v10, s47, v8
    v_lshlrev_b32 v10, 10, v10
    v_add_u32 v10, v10, v9
    v_add_u32 v10, s57, v10
    global_load_dwordx4 v[240:243], v10, s[24:25] nt
L_h_end:
    s_sub_u32 s58, s4, 2
    s_cmp_lt_u32 s58, 4
    s_cbranch_scc0 L_h_gu
    s_lshr_b32 s64, s46, 6
    s_lshl_b32 s58, s58, 3
    s_lshl_b32 s57, s64, 2
    s_add_u32 s58, s58, s57
    s_add_u32 s58, s58, 3
    s_cmp_lt_u32 s58, 28
    s_cbranch_scc0 L_h_gu
    s_and_b32 s47, s46, 31
    s_lshl_b32 s47, s47, 3
    v_add_u32 v10, s47, v8
    v_lshlrev_b32 v10, 1, v10
    v_add_u32 v10, s64, v10
    v_mul_u32_u24 v10, 3584, v10
    v_add_u32 v10, v10, v9
    s_lshl_b32 s58, s58, 7
    v_add_u32 v10, s58, v10
    s_bitcmp1_b32 s46, 5
    s_cbranch_scc1 L_h_gu_up
    global_load_dwordx4 v[220:223], v10, s[28:29] nt
    s_branch L_h_gu
L_h_gu_up:
    global_load_dwordx4 v[220:223], v10, s[30:31] nt
L_h_gu:
    s_mov_b32 s53, 0x3fb8aa3b
    s_mov_b32 s54, 0xbfb8aa3b
    s_mov_b32 s55, 0x3db504f3
    s_mov_b32 s68, 0x00003f80
    s_mov_b32 s69, 0x3f800000
    s_lshl_b32 s46, s4, 2
    s_add_u32 s46, s46, s44
    s_lshl_b32 s47, s4, 13
    s_lshl_b32 s57, s3, 10
    s_add_u32 s47, s47, s57
    s_lshl_b32 s57, s44, 6
    s_add_u32 s47, s47, s57
    s_add_u32 s47, s47, 65536
    s_add_u32 s64, s42, s47
    s_addc_u32 s65, s43, 0
    v_bfe_u32 v7, v1, 2, 2
    v_lshlrev_b32 v7, 8, v7
    v_and_b32 v8, 3, v1
    v_lshl_add_u32 v7, v8, 4, v7
    s_lshr_b32 s47, s3, 1
    s_mul_i32 s47, s47, 320
    s_and_b32 s57, s3, 1
    s_lshl_b32 s57, s57, 7
    s_add_u32 s47, s47, s57
    v_lshl_add_u32 v12, v1, 2, s47
    v_and_b32 v14, 3, v1
    v_mul_u32_u24 v13, 320, v14
    v_lshl_add_u32 v13, v3, 4, v13
    v_lshlrev_b32 v16, 5, v14
    s_lshl_b32 s47, s3, 2
    v_add_u32 v15, s47, v16
    v_mul_u32_u24 v18, 576, v14
    v_add_u32 v18, 1536, v18
    s_lshl_b32 s47, s3, 6
    v_lshl_add_u32 v17, v3, 3, v18
    v_add_u32 v17, s47, v17
    v_lshl_add_u32 v18, v3, 4, v18
    v_bfe_u32 v20, v1, 2, 2
    v_lshl_add_u32 v21, v3, 3, v20
    v_lshlrev_b32 v19, 8, v21
    v_and_b32 v21, 1, v3
    v_lshl_add_u32 v21, v21, 2, v20
    v_lshlrev_b32 v21, 1, v21
    v_bfe_u32 v22, v1, 1, 1
    s_lshl_b32 s47, s3, 1
    v_add_u32 v22, s47, v22
    v_xor_b32 v21, v21, v22
    v_lshl_add_u32 v19, v21, 4, v19
    v_and_b32 v21, 1, v1
    v_lshl_add_u32 v19, v21, 3, v19
    v_add_u32 v19, 82944, v19
    v_xor_b32 v4, v2, v3
    v_lshlrev_b32 v4, 4, v4
    v_lshl_add_u32 v204, v2, 8, v4
    s_add_u32 s47, s67, 17408
    v_xor_b32 v205, 64, v204
    v_xor_b32 v206, 128, v204
    v_xor_b32 v207, 192, v204
    v_add_u32 v204, s47, v204
    v_add_u32 v205, s47, v205
    v_add_u32 v206, s47, v206
    v_add_u32 v207, s47, v207
    s_lshl_b32 s47, s46, 2
    s_add_u32 s47, s47, s45
    s_lshl_b32 s57, s47, 10
    s_lshl_b32 s58, s3, 7
    s_add_u32 s57, s57, s58
    s_add_u32 s57, s57, 131072
    s_add_u32 s48, s42, s57
    s_addc_u32 s49, s43, 0
    v_lshlrev_b32 v23, 5, v14
    v_lshl_add_u32 v23, v3, 3, v23
    s_lshl_b32 s47, s47, 7
    s_add_u32 s47, s47, 262144
    s_add_u32 s50, s42, s47
    s_addc_u32 s51, s43, 0
    v_lshlrev_b32 v208, 2, v14
    s_waitcnt lgkmcnt(0)
    s_mul_i32 s6, s7, 1664525
    s_add_u32 s6, s6, 1013904223
    s_getreg_b32 s86, hwreg(HW_REG_XCC_ID, 0, 4)
    s_cmp_eq_u32 s3, 0
    s_cbranch_scc0 L_xcp_8
    s_lshl_b32 s57, s4, 8
    s_lshl_b32 s58, s5, 3
    s_add_u32 s57, s57, s58
    s_add_u32 s57, s57, 4096
    v_mov_b32 v250, s57
    v_mov_b32 v252, s86
    v_mov_b32 v253, s6
    s_mov_b64 exec, 1
    global_store_dwordx2 v250, v[252:253], s[42:43] sc1
    s_mov_b64 exec, -1
L_xcp_8:
    s_add_u32 s8, s18, s66
    s_addc_u32 s9, s19, 0
    s_add_u32 s12, s18, s59
    s_addc_u32 s13, s19, 0
    s_add_u32 m0, s67, 17408
    s_nop 0
    global_load_lds_dwordx4 v24, s[8:9] offset:0 nt
    global_load_lds_dwordx4 v25, s[8:9] offset:1024 nt
    global_load_lds_dwordx4 v26, s[8:9] offset:2048 nt
    global_load_lds_dwordx4 v27, s[8:9] offset:3072 nt
    s_add_u32 m0, s67, 21504
    s_nop 0
    global_load_lds_dwordx4 v24, s[12:13] offset:0 nt
    global_load_lds_dwordx4 v25, s[12:13] offset:1024 nt
    global_load_lds_dwordx4 v26, s[12:13] offset:2048 nt
    global_load_lds_dwordx4 v27, s[12:13] offset:3072 nt
    s_add_u32 s10, s20, s66
    s_addc_u32 s11, s21, 0
    s_add_u32 s14, s20, s59
    s_addc_u32 s15, s21, 0
    s_barrier
    s_add_u32 m0, s67, 82944
    s_nop 0
    global_load_lds_dwordx4 v5, s[10:11] offset:0 nt
    global_load_lds_dwordx4 v5, s[10:11] offset:1024 nt
    global_load_lds_dwordx4 v6, s[10:11] offset:2048 nt
    global_load_lds_dwordx4 v6, s[10:11] offset:3072 nt
    s_add_u32 m0, s67, 87040
    s_nop 0
    global_load_lds_dwordx4 v5, s[14:15] offset:0 nt
    global_load_lds_dwordx4 v5, s[14:15] offset:1024 nt
    global_load_lds_dwordx4 v6, s[14:15] offset:2048 nt
    global_load_lds_dwordx4 v6, s[14:15] offset:3072 nt
    v_min_u32 v250, 23, v1
    v_lshlrev_b32 v250, 3, v250
    s_lshl_b32 s57, s4, 8
    s_add_u32 s57, s57, 4096
    v_add_u32 v250, s57, v250
    global_load_dwordx2 v[252:253], v250, s[42:43] sc1
    v_and_b32 v209, 15, v1
    v_lshlrev_b32 v209, 7, v209
    v_add_u32 v209, 6144, v209
    global_load_dwordx2 v[210:211], v209, s[42:43] sc1
    s_waitcnt vmcnt(10)
    ds_read_b128 v[64:67], v204 offset:0
    ds_read_b128 v[68:71], v205 offset:0
    ds_read_b128 v[72:75], v206 offset:0
    ds_read_b128 v[76:79], v207 offset:0
    ds_read_b128 v[80:83], v204 offset:4096
    ds_read_b128 v[84:87], v205 offset:4096
    ds_read_b128 v[88:91], v206 offset:4096
    ds_read_b128 v[92:95], v207 offset:4096
    s_waitcnt lgkmcnt(0)
    s_mov_b32 s44, s3
    s_mov_b32 s45, s6
    s_mov_b32 s46, s2
L_qs_9:
    s_load_dwordx16 s[0:15], s[64:65], 0 glc
    s_load_dwordx16 s[16:31], s[64:65], 256 glc
    s_load_dwordx16 s[68:83], s[64:65], 512 glc
    s_load_dwordx16 s[84:99], s[64:65], 768 glc
    s_waitcnt lgkmcnt(0)
    s_cmp_lg_u32 s1, s45
    s_cbranch_scc1 L_qsr_10
    s_cmp_lg_u32 s9, s45
    s_cbranch_scc1 L_qsr_10
    s_cmp_lg_u32 s17, s45
    s_cbranch_scc1 L_qsr_10
    s_cmp_lg_u32 s25, s45
    s_cbranch_scc1 L_qsr_10
    s_cmp_lg_u32 s69, s45
    s_cbranch_scc1 L_qsr_10
    s_cmp_lg_u32 s77, s45
    s_cbranch_scc1 L_qsr_10
    s_cmp_lg_u32 s85, s45
    s_cbranch_scc1 L_qsr_10
    s_cmp_lg_u32 s93, s45
    s_cbranch_scc1 L_qsr_10
    v_writelane_b32 v8, s0, 0
    v_writelane_b32 v8, s2, 1
    v_writelane_b32 v8, s4, 2
    v_writelane_b32 v8, s6, 3
    v_writelane_b32 v8, s8, 4
    v_writelane_b32 v8, s10, 5
    v_writelane_b32 v8, s12, 6
    v_writelane_b32 v8, s14, 7
    v_writelane_b32 v8, s16, 8
    v_writelane_b32 v8, s18, 9
    v_writelane_b32 v8, s20, 10
    v_writelane_b32 v8, s22, 11
    v_writelane_b32 v8, s24, 12
    v_writelane_b32 v8, s26, 13
    v_writelane_b32 v8, s28, 14
    v_writelane_b32 v8, s30, 15
    v_writelane_b32 v8, s68, 16
    v_writelane_b32 v8, s70, 17
    v_writelane_b32 v8, s72, 18
    v_writelane_b32 v8, s74, 19
    v_writelane_b32 v8, s76, 20
    v_writelane_b32 v8, s78, 21
    v_writelane_b32 v8, s80, 22
    v_writelane_b32 v8, s82, 23
    v_writelane_b32 v8, s84, 24
    v_writelane_b32 v8, s86, 25
    v_writelane_b32 v8, s88, 26
    v_writelane_b32 v8, s90, 27
    v_writelane_b32 v8, s92, 28
    v_writelane_b32 v8, s94, 29
    v_writelane_b32 v8, s96, 30
    v_writelane_b32 v8, s98, 31
    s_mov_b32 s3, s44
    s_mov_b32 s6, s45
    s_mov_b32 s2, s46
    s_mov_b32 exec_hi, 0
    ds_write_b32 v12, v8 offset:0
    s_mov_b64 exec, -1
    s_waitcnt lgkmcnt(0)
    s_barrier
    ds_read_b128 v[28:31], v13 offset:0
    ds_read_b128 v[32:35], v13 offset:64
    ds_read_b128 v[36:39], v13 offset:128
    ds_read_b128 v[40:43], v13 offset:192
    s_waitcnt lgkmcnt(3)
    v_mfma_f32_16x16x32_bf16 v[44:47], v[64:67], v[28:31], 0
    v_mfma_f32_16x16x32_bf16 v[48:51], v[80:83], v[28:31], 0
    s_waitcnt lgkmcnt(2)
    v_mfma_f32_16x16x32_bf16 v[44:47], v[68:71], v[32:35], v[44:47]
    v_mfma_f32_16x16x32_bf16 v[48:51], v[84:87], v[32:35], v[48:51]
    s_waitcnt lgkmcnt(1)
    v_mfma_f32_16x16x32_bf16 v[44:47], v[72:75], v[36:39], v[44:47]
    v_mfma_f32_16x16x32_bf16 v[48:51], v[88:91], v[36:39], v[48:51]
    s_waitcnt lgkmcnt(0)
    v_mfma_f32_16x16x32_bf16 v[44:47], v[76:79], v[40:43], v[44:47]
    v_mfma_f32_16x16x32_bf16 v[48:51], v[92:95], v[40:43], v[48:51]
    s_nop 6
    v_cvt_pk_bf16_f32 v52, v44, v45
    v_cvt_pk_bf16_f32 v53, v46, v47
    v_lshlrev_b32 v44, 16, v52
    v_and_b32 v45, s52, v52
    v_lshlrev_b32 v46, 16, v53
    v_and_b32 v47, s52, v53
    v_cvt_pk_bf16_f32 v54, v48, v49
    v_cvt_pk_bf16_f32 v55, v50, v51
    v_lshlrev_b32 v48, 16, v54
    v_and_b32 v49, s52, v54
    v_lshlrev_b32 v50, 16, v55
    v_and_b32 v51, s52, v55
    v_mul_f32 v44, s55, v44
    v_mul_f32 v45, s55, v45
    v_mul_f32 v46, s55, v46
    v_mul_f32 v47, s55, v47
    v_mul_f32 v48, s55, v48
    v_mul_f32 v49, s55, v49
    v_mul_f32 v50, s55, v50
    v_mul_f32 v51, s55, v51
    v_cvt_pk_bf16_f32 v52, v44, v45
    v_cvt_pk_bf16_f32 v53, v46, v47
    v_lshlrev_b32 v44, 16, v52
    v_and_b32 v45, s52, v52
    v_lshlrev_b32 v46, 16, v53
    v_and_b32 v47, s52, v53
    v_cvt_pk_bf16_f32 v54, v48, v49
    v_cvt_pk_bf16_f32 v55, v50, v51
    v_lshlrev_b32 v48, 16, v54
    v_and_b32 v49, s52, v54
    v_lshlrev_b32 v50, 16, v55
    v_and_b32 v51, s52, v55
    v_max3_f32 v56, v44, v45, v46
    v_max3_f32 v57, v47, v48, v49
    v_max3_f32 v56, v56, v50, v51
    v_max_f32 v56, v56, v57
    v_mov_b32 v57, v56
    s_nop 1
    v_permlane16_swap_b32 v56, v57
    v_max_f32 v56, v56, v57
    v_mov_b32 v57, v56
    s_nop 1
    v_permlane32_swap_b32 v56, v57
    v_max_f32 v56, v56, v57
    s_mov_b64 exec, 15
    ds_write_b32 v15, v56 offset:1280
    s_mov_b64 exec, -1
    s_waitcnt lgkmcnt(0)
    s_barrier
    ds_read_b128 v[28:31], v16 offset:1280
    ds_read_b128 v[32:35], v16 offset:1296
    s_waitcnt lgkmcnt(0)
    v_max3_f32 v56, v28, v29, v30
    v_max3_f32 v57, v31, v32, v33
    v_max3_f32 v56, v56, v34, v35
    v_max_f32 v56, v56, v57
    v_mul_f32 v58, s54, v56
    v_fma_f32 v44, v44, s53, v58
    v_fma_f32 v45, v45, s53, v58
    v_fma_f32 v46, v46, s53, v58
    v_fma_f32 v47, v47, s53, v58
    v_fma_f32 v48, v48, s53, v58
    v_fma_f32 v49, v49, s53, v58
    v_fma_f32 v50, v50, s53, v58
    v_fma_f32 v51, v51, s53, v58
    v_exp_f32 v44, v44
    v_exp_f32 v45, v45
    v_exp_f32 v46, v46
    v_exp_f32 v47, v47
    v_exp_f32 v48, v48
    v_exp_f32 v49, v49
    v_exp_f32 v50, v50
    v_exp_f32 v51, v51
    v_cvt_pk_bf16_f32 v28, v44, v45
    v_cvt_pk_bf16_f32 v29, v46, v47
    v_cvt_pk_bf16_f32 v30, v48, v49
    v_cvt_pk_bf16_f32 v31, v50, v51
    s_mov_b64 exec, s[62:63]
    ds_write_b64 v17, v[28:29]
    ds_write_b64 v17, v[30:31] offset:32
    s_mov_b64 exec, -1
    v_add_f32 v44, v44, v45
    v_add_f32 v46, v46, v47
    v_add_f32 v48, v48, v49
    v_add_f32 v50, v50, v51
    v_add_f32 v44, v44, v46
    v_add_f32 v48, v48, v50
    v_add_f32 v57, v44, v48
    v_mov_b32 v59, v57
    s_nop 1
    v_permlane16_swap_b32 v57, v59
    v_add_f32 v57, v57, v59
    v_mov_b32 v59, v57
    s_nop 1
    v_permlane32_swap_b32 v57, v59
    v_add_f32 v57, v57, v59
    s_mov_b64 exec, 15
    ds_write_b32 v15, v57 offset:1408
    s_mov_b64 exec, -1
L_tchk_11:
    s_waitcnt vmcnt(0)
    v_cmp_ne_u32 s[88:89], s6, v211
    s_cmp_lg_u64 s[88:89], 0
    s_cbranch_scc1 L_tretry_12
    s_getreg_b32 s86, hwreg(HW_REG_XCC_ID, 0, 4)
    v_cmp_eq_u32 vcc, s6, v253
    v_cmp_eq_u32 s[60:61], s86, v252
    s_and_b64 vcc, vcc, s[60:61]
    s_cmp_eq_u64 vcc, exec
    s_cselect_b32 s87, 1, 0
    s_waitcnt lgkmcnt(0)
    s_barrier
    ds_read_b128 v[28:31], v16 offset:1408
    ds_read_b128 v[32:35], v16 offset:1424
    ds_read_b64_tr_b16 v[128:129], v19 offset:0
    ds_read_b64_tr_b16 v[130:131], v19 offset:1024
    ds_read_b128 v[96:99], v18 offset:0
    ds_read_b64_tr_b16 v[132:133], v19 offset:8192
    ds_read_b64_tr_b16 v[134:135], v19 offset:9216
    ds_read_b128 v[100:103], v18 offset:64
    ds_read_b64_tr_b16 v[136:137], v19 offset:16384
    ds_read_b64_tr_b16 v[138:139], v19 offset:17408
    ds_read_b128 v[104:107], v18 offset:128
    ds_read_b64_tr_b16 v[140:141], v19 offset:24576
    ds_read_b64_tr_b16 v[142:143], v19 offset:25600
    ds_read_b128 v[108:111], v18 offset:192
    s_waitcnt lgkmcnt(9)
    v_mfma_f32_16x16x32_bf16 v[36:39], v[128:131], v[96:99], 0
    ds_read_b64_tr_b16 v[144:145], v19 offset:32768
    ds_read_b64_tr_b16 v[146:147], v19 offset:33792
    ds_read_b128 v[112:115], v18 offset:256
    s_waitcnt lgkmcnt(9)
    v_mfma_f32_16x16x32_bf16 v[36:39], v[132:135], v[100:103], v[36:39]
    ds_read_b64_tr_b16 v[148:149], v19 offset:40960
    ds_read_b64_tr_b16 v[150:151], v19 offset:41984
    ds_read_b128 v[116:119], v18 offset:320
    s_waitcnt lgkmcnt(9)
    v_mfma_f32_16x16x32_bf16 v[36:39], v[136:139], v[104:107], v[36:39]
    ds_read_b64_tr_b16 v[152:153], v19 offset:49152
    ds_read_b64_tr_b16 v[154:155], v19 offset:50176
    ds_read_b128 v[120:123], v18 offset:384
    s_waitcnt lgkmcnt(9)
    v_mfma_f32_16x16x32_bf16 v[36:39], v[140:143], v[108:111], v[36:39]
    ds_read_b64_tr_b16 v[156:157], v19 offset:57344
    ds_read_b64_tr_b16 v[158:159], v19 offset:58368
    ds_read_b128 v[124:127], v18 offset:448
    s_waitcnt lgkmcnt(9)
    v_mfma_f32_16x16x32_bf16 v[36:39], v[144:147], v[112:115], v[36:39]
    s_waitcnt lgkmcnt(6)
    v_mfma_f32_16x16x32_bf16 v[36:39], v[148:151], v[116:119], v[36:39]
    s_waitcnt lgkmcnt(3)
    v_mfma_f32_16x16x32_bf16 v[36:39], v[152:155], v[120:123], v[36:39]
    s_waitcnt lgkmcnt(0)
    v_mfma_f32_16x16x32_bf16 v[36:39], v[156:159], v[124:127], v[36:39]
    v_add_f32 v28, v28, v29
    v_add_f32 v30, v30, v31
    v_add_f32 v32, v32, v33
    v_add_f32 v34, v34, v35
    v_add_f32 v28, v28, v30
    v_add_f32 v32, v32, v34
    v_add_f32 v28, v28, v32
    v_rcp_f32 v29, v28
    v_log_f32 v60, v28
    v_mul_f32 v36, v36, v29
    v_mul_f32 v37, v37, v29
    v_mul_f32 v38, v38, v29
    v_mul_f32 v39, v39, v29
    v_cvt_pk_bf16_f32 v200, v36, v37
    v_cvt_pk_bf16_f32 v201, v38, v39
    v_sub_f32 v60, v60, v58
    v_min_u32 v200, -2, v200
    v_min_u32 v201, -2, v201
    v_min_u32 v60, -2, v60
    s_mov_b64 exec, s[62:63]
    s_cmp_eq_u32 s87, 1
    s_cbranch_scc1 L_st_13
    global_store_dwordx2 v23, v[200:201], s[48:49] sc1
    s_branch L_ste_14
L_st_13:
    global_store_dwordx2 v23, v[200:201], s[48:49]
L_ste_14:
    s_cmp_eq_u32 s3, 0
    s_cbranch_scc0 L_att_nolse
    s_mov_b64 exec, 15
    s_cmp_eq_u32 s87, 1
    s_cbranch_scc1 L_st_15
    global_store_dword v208, v60, s[50:51] sc1
    s_branch L_ste_16
L_st_15:
    global_store_dword v208, v60, s[50:51]
L_ste_16:
L_att_nolse:
    s_mov_b64 exec, -1
    s_branch L_FIN
L_FFN:
    s_sub_u32 s66, s66, 16
    v_lshrrev_b32 v4, 3, v1
    s_mov_b32 s57, 3584
    v_mul_lo_u32 v20, s57, v4
    v_bfe_u32 v4, v1, 1, 2
    v_bfe_u32 v5, v1, 4, 1
    v_xor_b32 v4, v4, v5
    v_lshl_add_u32 v20, v4, 5, v20
    v_and_b32 v4, 1, v1
    v_lshl_add_u32 v20, v4, 4, v20
    v_xor_b32 v21, 64, v20
    v_mov_b32 v22, v20
    v_mov_b32 v23, v21
    s_mul_i32 s46, s3, 229376
    s_lshl_b32 s47, s66, 7
    s_add_u32 s46, s46, s47
    s_lshl_b32 s67, s3, 13
    s_add_u32 s67, s67, 17408
    s_waitcnt lgkmcnt(0)
    s_load_dword s7, s[42:43], 0
    s_add_u32 s8, s28, s46
    s_addc_u32 s9, s29, 0
    s_add_u32 s10, s30, s46
    s_addc_u32 s11, s31, 0
    s_mov_b32 s53, 0x3fb8aa3b
    s_mov_b32 s54, 0xbfb8aa3b
    s_mov_b32 s55, 0x3db504f3
    s_mov_b32 s68, 0x00003f80
    s_mov_b32 s69, 0x3f800000
    s_lshl_b32 s58, s66, 16
    v_min_u32 v227, 1, v1
    v_lshlrev_b32 v227, 15, v227
    v_add_u32 v227, s58, v227
    global_load_dword v246, v227, s[32:33]
    s_add_u32 s46, s67, 65536
    s_mov_b32 m0, s46
    s_nop 0
    global_load_lds_dwordx4 v20, s[8:9] nt
    s_add_u32 m0, s46, 1024
    v_add_u32 v21, 28672, v21
    global_load_lds_dwordx4 v21, s[8:9] nt
    s_add_u32 m0, s46, 2048
    v_add_u32 v20, 57344, v20
    global_load_lds_dwordx4 v20, s[8:9] nt
    s_add_u32 m0, s46, 3072
    v_add_u32 v21, 57344, v21
    global_load_lds_dwordx4 v21, s[8:9] nt
    s_add_u32 m0, s46, 4096
    v_add_u32 v20, 57344, v20
    global_load_lds_dwordx4 v20, s[8:9] nt
    s_add_u32 m0, s46, 5120
    v_add_u32 v21, 57344, v21
    global_load_lds_dwordx4 v21, s[8:9] nt
    s_add_u32 m0, s46, 6144
    v_add_u32 v20, 57344, v20
    global_load_lds_dwordx4 v20, s[8:9] nt
    s_add_u32 m0, s46, 7168
    v_add_u32 v21, 57344, v21
    global_load_lds_dwordx4 v21, s[8:9] nt
    s_mov_b32 m0, s67
    s_nop 0
    global_load_lds_dwordx4 v22, s[10:11] nt
    s_add_u32 m0, s67, 1024
    v_add_u32 v23, 28672, v23
    global_load_lds_dwordx4 v23, s[10:11] nt
    s_add_u32 m0, s67, 2048
    v_add_u32 v22, 57344, v22
    global_load_lds_dwordx4 v22, s[10:11] nt
    s_add_u32 m0, s67, 3072
    v_add_u32 v23, 57344, v23
    global_load_lds_dwordx4 v23, s[10:11] nt
    s_add_u32 m0, s67, 4096
    v_add_u32 v22, 57344, v22
    global_load_lds_dwordx4 v22, s[10:11] nt
    s_add_u32 m0, s67, 5120
    v_add_u32 v23, 57344, v23
    global_load_lds_dwordx4 v23, s[10:11] nt
    s_add_u32 m0, s67, 6144
    v_add_u32 v22, 57344, v22
    global_load_lds_dwordx4 v22, s[10:11] nt
    s_add_u32 m0, s67, 7168
    v_add_u32 v23, 57344, v23
    global_load_lds_dwordx4 v23, s[10:11] nt
    s_and_b32 s57, s3, 1
    s_lshl_b32 s57, s57, 3
    v_xor_b32 v232, s57, v1
    v_lshlrev_b32 v232, 4, v232
    v_xor_b32 v233, 32, v232
    v_xor_b32 v234, 64, v232
    v_xor_b32 v235, 96, v232
    s_lshl_b32 s46, s66, 16
    s_lshl_b32 s47, s3, 13
    s_add_u32 s46, s46, s47
    s_add_u32 s48, s32, s46
    s_addc_u32 s49, s33, 0
    s_add_u32 s46, s46, 4096
    s_add_u32 s50, s32, s46
    s_addc_u32 s51, s33, 0
    global_load_dwordx4 v[96:99], v232, s[48:49] offset:0 nt
    global_load_dwordx4 v[100:103], v233, s[48:49] offset:1024 nt
    global_load_dwordx4 v[104:107], v234, s[48:49] offset:2048 nt
    global_load_dwordx4 v[108:111], v235, s[48:49] offset:3072 nt
    global_load_dwordx4 v[112:115], v232, s[50:51] offset:0 nt
    global_load_dwordx4 v[116:119], v233, s[50:51] offset:1024 nt
    global_load_dwordx4 v[120:123], v234, s[50:51] offset:2048 nt
    global_load_dwordx4 v[124:127], v235, s[50:51] offset:3072 nt
    s_waitcnt lgkmcnt(0)
    s_mul_i32 s6, s7, 1664525
    s_add_u32 s6, s6, 1013904223
    v_bfe_u32 v2, v0, 2, 2
    v_lshrrev_b32 v3, 4, v0
    v_lshlrev_b32 v3, 5, v3
    v_and_b32 v254, 3, v0
    v_lshl_add_u32 v3, v254, 3, v3
    v_lshl_add_u32 v4, v2, 10, v3
    global_load_dwordx2 v[6:7], v4, s[16:17]
    v_lshlrev_b32 v5, 4, v0
    v_add_u32 v15, 8192, v5
    v_add_u32 v17, 16384, v5
    s_add_u32 s8, s42, 0x7000
    s_addc_u32 s9, s43, 0
    v_lshlrev_b32 v8, 3, v0
    v_add_u32 v18, 8192, v8
    s_add_u32 s10, s42, 0x45000
    s_addc_u32 s11, s43, 0
    s_add_u32 s12, s42, 0x49000
    s_addc_u32 s13, s43, 0
    v_mul_u32_u24 v9, 1088, v2
    v_add_u32 v9, v9, v3
    v_lshlrev_b32 v11, 6, v2
    v_add_u32 v11, 8704, v11
    s_lshl_b32 s57, s3, 3
    v_add_u32 v10, s57, v11
    v_lshrrev_b32 v12, 4, v1
    v_bfe_u32 v13, v1, 2, 2
    v_lshl_add_u32 v14, v12, 3, v13
    v_lshlrev_b32 v14, 7, v14
    v_and_b32 v12, 1, v12
    v_lshrrev_b32 v13, 1, v13
    v_lshl_add_u32 v12, v12, 1, v13
    s_lshr_b32 s57, s3, 1
    v_xor_b32 v12, s57, v12
    v_lshl_add_u32 v14, v12, 5, v14
    s_and_b32 s57, s3, 1
    s_lshl_b32 s57, s57, 4
    v_add_u32 v14, s57, v14
    v_and_b32 v12, 1, v1
    v_lshl_add_u32 v14, v12, 3, v14
    v_bfe_u32 v12, v1, 1, 1
    v_mul_u32_u24 v12, 65536, v12
    v_sub_u32 v14, v14, v12
    v_add_u32 v14, 82944, v14
    s_waitcnt vmcnt(9)
    s_barrier
    ds_read_b64_tr_b16 v[160:161], v14 offset:0
    ds_read_b64_tr_b16 v[162:163], v14 offset:512
    ds_read_b64_tr_b16 v[164:165], v14 offset:4096
    ds_read_b64_tr_b16 v[166:167], v14 offset:4608
    ds_read_b64_tr_b16 v[168:169], v14 offset:8192
    ds_read_b64_tr_b16 v[170:171], v14 offset:8704
    ds_read_b64_tr_b16 v[172:173], v14 offset:12288
    ds_read_b64_tr_b16 v[174:175], v14 offset:12800
    ds_read_b64_tr_b16 v[176:177], v14 offset:16384
    ds_read_b64_tr_b16 v[178:179], v14 offset:16896
    ds_read_b64_tr_b16 v[180:181], v14 offset:20480
    ds_read_b64_tr_b16 v[182:183], v14 offset:20992
    s_waitcnt lgkmcnt(8)
    ds_read_b64_tr_b16 v[184:185], v14 offset:24576
    ds_read_b64_tr_b16 v[186:187], v14 offset:25088
    ds_read_b64_tr_b16 v[188:189], v14 offset:28672
    ds_read_b64_tr_b16 v[190:191], v14 offset:29184
    s_waitcnt lgkmcnt(8)
    ds_read_b64_tr_b16 v[192:193], v14 offset:32768
    ds_read_b64_tr_b16 v[194:195], v14 offset:33280
    ds_read_b64_tr_b16 v[196:197], v14 offset:36864
    ds_read_b64_tr_b16 v[198:199], v14 offset:37376
    s_waitcnt lgkmcnt(8)
    ds_read_b64_tr_b16 v[200:201], v14 offset:40960
    ds_read_b64_tr_b16 v[202:203], v14 offset:41472
    ds_read_b64_tr_b16 v[204:205], v14 offset:45056
    ds_read_b64_tr_b16 v[206:207], v14 offset:45568
    s_waitcnt lgkmcnt(8)
    ds_read_b64_tr_b16 v[208:209], v14 offset:49152
    ds_read_b64_tr_b16 v[210:211], v14 offset:49664
    ds_read_b64_tr_b16 v[212:213], v14 offset:53248
    ds_read_b64_tr_b16 v[214:215], v14 offset:53760
    s_waitcnt lgkmcnt(8)
    ds_read_b64_tr_b16 v[216:217], v14 offset:57344
    ds_read_b64_tr_b16 v[218:219], v14 offset:57856
    ds_read_b64_tr_b16 v[220:221], v14 offset:61440
    ds_read_b64_tr_b16 v[222:223], v14 offset:61952
    v_lshrrev_b32 v12, 4, v1
    v_bfe_u32 v13, v1, 2, 2
    v_lshl_add_u32 v236, v12, 3, v13
    v_lshlrev_b32 v236, 10, v236
    v_and_b32 v12, 1, v12
    v_lshl_add_u32 v12, v12, 2, v13
    v_lshl_add_u32 v236, v12, 5, v236
    v_bfe_u32 v12, v1, 1, 1
    v_lshl_add_u32 v236, v12, 4, v236
    v_and_b32 v12, 1, v1
    v_lshl_add_u32 v236, v12, 3, v236
    s_lshl_b32 s57, s3, 7
    v_xor_b32 v236, s57, v236
    v_xor_b32 v237, 32, v236
    v_xor_b32 v238, 64, v236
    v_xor_b32 v239, 96, v236
    v_add_u32 v236, 17408, v236
    v_add_u32 v237, 17408, v237
    v_add_u32 v238, 17408, v238
    v_add_u32 v239, 17408, v239
    v_and_b32 v12, 3, v1
    v_mul_u32_u24 v240, 192, v12
    v_lshrrev_b32 v13, 4, v1
    v_lshl_add_u32 v241, v13, 4, v240
    v_lshl_add_u32 v240, v13, 3, v240
    s_lshl_b32 s57, s3, 4
    v_add_u32 v240, s57, v240
    v_lshlrev_b32 v242, 5, v12
    v_lshl_add_u32 v242, v13, 3, v242
    v_add_u32 v243, 7168, v242
    s_mul_i32 s46, s3, 14336
    s_lshl_b32 s47, s66, 8
    s_add_u32 s46, s46, s47
    s_add_u32 s46, s46, 327680
    s_add_u32 s14, s42, s46
    s_addc_u32 s15, s43, 0
    v_and_b32 v13, 3, v1
    v_mul_u32_u24 v12, 1088, v13
    v_lshrrev_b32 v13, 4, v1
    v_lshl_add_u32 v12, v13, 4, v12
    s_waitcnt lgkmcnt(0)
    s_barrier
    v_lshlrev_b32 v13, 4, v1
    v_add_u32 v13, s67, v13
    s_waitcnt vmcnt(1)
    ds_write_b128 v13, v[96:99] offset:0
    ds_write_b128 v13, v[100:103] offset:1024
    ds_write_b128 v13, v[104:107] offset:2048
    ds_write_b128 v13, v[108:111] offset:3072
    ds_write_b128 v13, v[112:115] offset:4096
    ds_write_b128 v13, v[116:119] offset:5120
    ds_write_b128 v13, v[120:123] offset:6144
    ds_write_b128 v13, v[124:127] offset:7168
    s_waitcnt lgkmcnt(0)
    s_barrier
    ds_read_b64_tr_b16 v[128:129], v236 offset:0
    ds_read_b64_tr_b16 v[130:131], v236 offset:4096
    ds_read_b64_tr_b16 v[132:133], v237 offset:0
    ds_read_b64_tr_b16 v[134:135], v237 offset:4096
    ds_read_b64_tr_b16 v[136:137], v238 offset:0
    ds_read_b64_tr_b16 v[138:139], v238 offset:4096
    ds_read_b64_tr_b16 v[140:141], v239 offset:0
    ds_read_b64_tr_b16 v[142:143], v239 offset:4096
    s_waitcnt lgkmcnt(7)
    ds_read_b64_tr_b16 v[144:145], v236 offset:32768
    ds_read_b64_tr_b16 v[146:147], v236 offset:36864
    ds_read_b64_tr_b16 v[148:149], v237 offset:32768
    ds_read_b64_tr_b16 v[150:151], v237 offset:36864
    ds_read_b64_tr_b16 v[152:153], v238 offset:32768
    ds_read_b64_tr_b16 v[154:155], v238 offset:36864
    ds_read_b64_tr_b16 v[156:157], v239 offset:32768
    ds_read_b64_tr_b16 v[158:159], v239 offset:36864
    global_load_dwordx4 v[48:51], v5, s[8:9] offset:-4096 sc1
    global_load_dwordx4 v[52:55], v15, s[8:9] offset:-4096 sc1
    global_load_dwordx4 v[56:59], v17, s[8:9] offset:-4096 sc1
L_tchk_17:
    s_waitcnt vmcnt(0)
    v_cmp_ne_u32 s[88:89], s6, v49
    v_cmp_ne_u32 s[90:91], s6, v53
    s_or_b64 s[60:61], s[88:89], s[90:91]
    v_cmp_ne_u32 s[92:93], s6, v57
    s_or_b64 s[60:61], s[60:61], s[92:93]
    s_cmp_lg_u64 s[60:61], 0
    s_cbranch_scc1 L_tretry_18
    v_lshlrev_b32 v32, 16, v6
    v_and_b32 v33, s52, v6
    v_lshlrev_b32 v34, 16, v7
    v_and_b32 v35, s52, v7
    v_lshlrev_b32 v36, 16, v48
    v_and_b32 v37, s52, v48
    v_lshlrev_b32 v38, 16, v50
    v_and_b32 v39, s52, v50
    v_lshlrev_b32 v40, 16, v52
    v_and_b32 v41, s52, v52
    v_lshlrev_b32 v42, 16, v54
    v_and_b32 v43, s52, v54
    v_lshlrev_b32 v44, 16, v56
    v_and_b32 v45, s52, v56
    v_lshlrev_b32 v46, 16, v58
    v_and_b32 v47, s52, v58
    v_add_f32 v44, 1.0, v44
    v_add_f32 v45, 1.0, v45
    v_add_f32 v46, 1.0, v46
    v_add_f32 v47, 1.0, v47
    v_cvt_pk_bf16_f32 v28, v44, v45
    v_cvt_pk_bf16_f32 v29, v46, v47
    v_lshlrev_b32 v44, 16, v28
    v_and_b32 v45, s52, v28
    v_lshlrev_b32 v46, 16, v29
    v_and_b32 v47, s52, v29
    v_cvt_pk_bf16_f32 v28, v44, v45
    v_cvt_pk_bf16_f32 v29, v46, v47
    v_cvt_pk_bf16_f32 v30, v40, v41
    v_cvt_pk_bf16_f32 v31, v42, v43
    ds_write_b64 v9, v[28:29] offset:0
    ds_write_b64 v9, v[30:31] offset:4352
    s_waitcnt lgkmcnt(0)
    s_barrier
    ds_read_b128 v[64:67], v12 offset:0
    ds_read_b128 v[68:71], v12 offset:64
    ds_read_b128 v[72:75], v12 offset:128
    ds_read_b128 v[76:79], v12 offset:192
    ds_read_b128 v[80:83], v12 offset:256
    ds_read_b128 v[84:87], v12 offset:320
    ds_read_b128 v[88:91], v12 offset:384
    ds_read_b128 v[92:95], v12 offset:448
    s_waitcnt lgkmcnt(7)
    v_mfma_f32_16x16x32_bf16 v[112:115], v[160:163], v[64:67], 0
    ds_read_b128 v[64:67], v12 offset:512
    s_waitcnt lgkmcnt(7)
    v_mfma_f32_16x16x32_bf16 v[112:115], v[164:167], v[68:71], v[112:115]
    ds_read_b128 v[68:71], v12 offset:576
    s_waitcnt lgkmcnt(7)
    v_mfma_f32_16x16x32_bf16 v[112:115], v[168:171], v[72:75], v[112:115]
    ds_read_b128 v[72:75], v12 offset:640
    s_waitcnt lgkmcnt(7)
    v_mfma_f32_16x16x32_bf16 v[112:115], v[172:175], v[76:79], v[112:115]
    ds_read_b128 v[76:79], v12 offset:704
    s_waitcnt lgkmcnt(7)
    v_mfma_f32_16x16x32_bf16 v[112:115], v[176:179], v[80:83], v[112:115]
    ds_read_b128 v[80:83], v12 offset:768
    s_waitcnt lgkmcnt(7)
    v_mfma_f32_16x16x32_bf16 v[112:115], v[180:183], v[84:87], v[112:115]
    ds_read_b128 v[84:87], v12 offset:832
    s_waitcnt lgkmcnt(7)
    v_mfma_f32_16x16x32_bf16 v[112:115], v[184:187], v[88:91], v[112:115]
    ds_read_b128 v[88:91], v12 offset:896
    s_waitcnt lgkmcnt(7)
    v_mfma_f32_16x16x32_bf16 v[112:115], v[188:191], v[92:95], v[112:115]
    ds_read_b128 v[92:95], v12 offset:960
    s_waitcnt lgkmcnt(7)
    v_mfma_f32_16x16x32_bf16 v[112:115], v[192:195], v[64:67], v[112:115]
    s_waitcnt lgkmcnt(6)
    v_mfma_f32_16x16x32_bf16 v[112:115], v[196:199], v[68:71], v[112:115]
    s_waitcnt lgkmcnt(5)
    v_mfma_f32_16x16x32_bf16 v[112:115], v[200:203], v[72:75], v[112:115]
    s_waitcnt lgkmcnt(4)
    v_mfma_f32_16x16x32_bf16 v[112:115], v[204:207], v[76:79], v[112:115]
    s_waitcnt lgkmcnt(3)
    v_mfma_f32_16x16x32_bf16 v[112:115], v[208:211], v[80:83], v[112:115]
    s_waitcnt lgkmcnt(2)
    v_mfma_f32_16x16x32_bf16 v[112:115], v[212:215], v[84:87], v[112:115]
    s_waitcnt lgkmcnt(1)
    v_mfma_f32_16x16x32_bf16 v[112:115], v[216:219], v[88:91], v[112:115]
    s_waitcnt lgkmcnt(0)
    v_mfma_f32_16x16x32_bf16 v[112:115], v[220:223], v[92:95], v[112:115]
    ds_read_b128 v[64:67], v12 offset:4352
    ds_read_b128 v[68:71], v12 offset:4416
    ds_read_b128 v[72:75], v12 offset:4480
    ds_read_b128 v[76:79], v12 offset:4544
    ds_read_b128 v[80:83], v12 offset:4608
    ds_read_b128 v[84:87], v12 offset:4672
    ds_read_b128 v[88:91], v12 offset:4736
    ds_read_b128 v[92:95], v12 offset:4800
    s_waitcnt lgkmcnt(7)
    v_mfma_f32_16x16x32_bf16 v[116:119], v[160:163], v[64:67], 0
    ds_read_b128 v[64:67], v12 offset:4864
    s_waitcnt lgkmcnt(7)
    v_mfma_f32_16x16x32_bf16 v[116:119], v[164:167], v[68:71], v[116:119]
    ds_read_b128 v[68:71], v12 offset:4928
    s_waitcnt lgkmcnt(7)
    v_mfma_f32_16x16x32_bf16 v[116:119], v[168:171], v[72:75], v[116:119]
    ds_read_b128 v[72:75], v12 offset:4992
    s_waitcnt lgkmcnt(7)
    v_mfma_f32_16x16x32_bf16 v[116:119], v[172:175], v[76:79], v[116:119]
    ds_read_b128 v[76:79], v12 offset:5056
    s_waitcnt lgkmcnt(7)
    v_mfma_f32_16x16x32_bf16 v[116:119], v[176:179], v[80:83], v[116:119]
    ds_read_b128 v[80:83], v12 offset:5120
    s_waitcnt lgkmcnt(7)
    v_mfma_f32_16x16x32_bf16 v[116:119], v[180:183], v[84:87], v[116:119]
    ds_read_b128 v[84:87], v12 offset:5184
    s_waitcnt lgkmcnt(7)
    v_mfma_f32_16x16x32_bf16 v[116:119], v[184:187], v[88:91], v[116:119]
    ds_read_b128 v[88:91], v12 offset:5248
    s_waitcnt lgkmcnt(7)
    v_mfma_f32_16x16x32_bf16 v[116:119], v[188:191], v[92:95], v[116:119]
    ds_read_b128 v[92:95], v12 offset:5312
    s_waitcnt lgkmcnt(7)
    v_mfma_f32_16x16x32_bf16 v[116:119], v[192:195], v[64:67], v[116:119]
    s_waitcnt lgkmcnt(6)
    v_mfma_f32_16x16x32_bf16 v[116:119], v[196:199], v[68:71], v[116:119]
    s_waitcnt lgkmcnt(5)
    v_mfma_f32_16x16x32_bf16 v[116:119], v[200:203], v[72:75], v[116:119]
    s_waitcnt lgkmcnt(4)
    v_mfma_f32_16x16x32_bf16 v[116:119], v[204:207], v[76:79], v[116:119]
    s_waitcnt lgkmcnt(3)
    v_mfma_f32_16x16x32_bf16 v[116:119], v[208:211], v[80:83], v[116:119]
    s_waitcnt lgkmcnt(2)
    v_mfma_f32_16x16x32_bf16 v[116:119], v[212:215], v[84:87], v[116:119]
    s_waitcnt lgkmcnt(1)
    v_mfma_f32_16x16x32_bf16 v[116:119], v[216:219], v[88:91], v[116:119]
    s_waitcnt lgkmcnt(0)
    v_mfma_f32_16x16x32_bf16 v[116:119], v[220:223], v[92:95], v[116:119]
    v_and_b32 v13, 3, v1
    v_lshlrev_b32 v19, 6, v13
    v_add_u32 v19, 8704, v19
    s_waitcnt lgkmcnt(0)
    s_barrier
    global_load_dwordx2 v[96:97], v8, s[10:11] offset:-4096 sc1
    global_load_dwordx2 v[98:99], v8, s[10:11] offset:0 sc1
    global_load_dwordx2 v[100:101], v18, s[10:11] offset:-4096 sc1
    global_load_dwordx2 v[102:103], v18, s[10:11] offset:0 sc1
    global_load_dwordx2 v[104:105], v8, s[12:13] offset:-4096 sc1
    global_load_dwordx2 v[106:107], v8, s[12:13] offset:0 sc1
    global_load_dwordx2 v[108:109], v18, s[12:13] offset:-4096 sc1
    global_load_dwordx2 v[110:111], v18, s[12:13] offset:0 sc1
L_schk_19:
    s_waitcnt vmcnt(0)
    v_max_u32 v254, v96, v97
    v_cmp_eq_u32 s[88:89], -1, v254
    v_max_u32 v254, v98, v99
    v_cmp_eq_u32 s[90:91], -1, v254
    s_or_b64 s[60:61], s[88:89], s[90:91]
    v_max_u32 v254, v100, v101
    v_cmp_eq_u32 s[92:93], -1, v254
    s_or_b64 s[60:61], s[60:61], s[92:93]
    v_max_u32 v254, v102, v103
    v_cmp_eq_u32 s[94:95], -1, v254
    s_or_b64 s[60:61], s[60:61], s[94:95]
    v_max_u32 v254, v104, v105
    v_cmp_eq_u32 s[96:97], -1, v254
    s_or_b64 s[60:61], s[60:61], s[96:97]
    v_max_u32 v254, v106, v107
    v_cmp_eq_u32 s[98:99], -1, v254
    s_or_b64 s[60:61], s[60:61], s[98:99]
    v_max_u32 v254, v108, v109
    v_cmp_eq_u32 s[26:27], -1, v254
    s_or_b64 s[60:61], s[60:61], s[26:27]
    v_max_u32 v254, v110, v111
    v_cmp_eq_u32 s[0:1], -1, v254
    s_or_b64 s[60:61], s[60:61], s[0:1]
    s_cmp_lg_u64 s[60:61], 0
    s_cbranch_scc1 L_sretry_20
    v_lshlrev_b32 v48, 16, v96
    v_and_b32 v49, s52, v96
    v_lshlrev_b32 v50, 16, v97
    v_and_b32 v51, s52, v97
    v_dot2c_f32_bf16 v48, s68, v98
    v_dot2c_f32_bf16 v49, s69, v98
    v_dot2c_f32_bf16 v50, s68, v99
    v_dot2c_f32_bf16 v51, s69, v99
    v_dot2c_f32_bf16 v48, s68, v100
    v_dot2c_f32_bf16 v49, s69, v100
    v_dot2c_f32_bf16 v50, s68, v101
    v_dot2c_f32_bf16 v51, s69, v101
    v_dot2c_f32_bf16 v48, s68, v102
    v_dot2c_f32_bf16 v49, s69, v102
    v_dot2c_f32_bf16 v50, s68, v103
    v_dot2c_f32_bf16 v51, s69, v103
    v_dot2c_f32_bf16 v48, s68, v104
    v_dot2c_f32_bf16 v49, s69, v104
    v_dot2c_f32_bf16 v50, s68, v105
    v_dot2c_f32_bf16 v51, s69, v105
    v_dot2c_f32_bf16 v48, s68, v106
    v_dot2c_f32_bf16 v49, s69, v106
    v_dot2c_f32_bf16 v50, s68, v107
    v_dot2c_f32_bf16 v51, s69, v107
    v_dot2c_f32_bf16 v48, s68, v108
    v_dot2c_f32_bf16 v49, s69, v108
    v_dot2c_f32_bf16 v50, s68, v109
    v_dot2c_f32_bf16 v51, s69, v109
    v_dot2c_f32_bf16 v48, s68, v110
    v_dot2c_f32_bf16 v49, s69, v110
    v_dot2c_f32_bf16 v50, s68, v111
    v_dot2c_f32_bf16 v51, s69, v111
    v_fmac_f32 v32, v36, v48
    v_fmac_f32 v33, v37, v49
    v_fmac_f32 v34, v38, v50
    v_fmac_f32 v35, v39, v51
    v_mul_f32 v44, v32, v44
    v_mul_f32 v45, v33, v45
    v_mul_f32 v46, v34, v46
    v_mul_f32 v47, v35, v47
    v_cvt_pk_bf16_f32 v28, v44, v45
    v_cvt_pk_bf16_f32 v29, v46, v47
    ds_write_b64 v9, v[28:29] offset:4352
    v_add_f32 v52, v32, v33
    v_mul_f32 v53, v32, v32
    v_add_f32 v54, v34, v35
    v_fmac_f32 v53, v33, v33
    v_add_f32 v52, v52, v54
    v_fmac_f32 v53, v34, v34
    v_fmac_f32 v53, v35, v35
    v_add_f32_dpp v52, v52, v52 quad_perm:[1,0,3,2] row_mask:0xf bank_mask:0xf
    s_nop 0
    v_add_f32_dpp v53, v53, v53 quad_perm:[1,0,3,2] row_mask:0xf bank_mask:0xf
    v_add_f32_dpp v52, v52, v52 quad_perm:[2,3,0,1] row_mask:0xf bank_mask:0xf
    s_nop 0
    v_add_f32_dpp v53, v53, v53 quad_perm:[2,3,0,1] row_mask:0xf bank_mask:0xf
    v_mov_b32 v54, v52
    v_mov_b32 v55, v53
    s_nop 0
    v_permlane16_swap_b32 v52, v54
    v_permlane16_swap_b32 v53, v55
    v_add_f32 v52, v52, v54
    v_add_f32 v53, v53, v55
    v_mov_b32 v54, v52
    v_mov_b32 v55, v53
    s_nop 0
    v_permlane32_swap_b32 v52, v54
    v_permlane32_swap_b32 v53, v55
    v_add_f32 v52, v52, v54
    v_add_f32 v53, v53, v55
    s_mov_b64 exec, 0x1111
    ds_write_b64 v10, v[52:53]
    s_mov_b64 exec, -1
    s_waitcnt lgkmcnt(0)
    s_barrier
    ds_read_b128 v[64:67], v12 offset:4352
    ds_read_b128 v[68:71], v12 offset:4416
    ds_read_b128 v[72:75], v12 offset:4480
    ds_read_b128 v[76:79], v12 offset:4544
    ds_read_b128 v[80:83], v12 offset:4608
    ds_read_b128 v[84:87], v12 offset:4672
    ds_read_b128 v[40:43], v19 offset:0
    ds_read_b128 v[44:47], v19 offset:16
    ds_read_b128 v[48:51], v19 offset:32
    ds_read_b128 v[52:55], v19 offset:48
    s_waitcnt lgkmcnt(9)
    v_mfma_f32_16x16x32_bf16 v[32:35], v[160:163], v[64:67], 0
    ds_read_b128 v[64:67], v12 offset:4736
    s_waitcnt lgkmcnt(9)
    v_mfma_f32_16x16x32_bf16 v[32:35], v[164:167], v[68:71], v[32:35]
    ds_read_b128 v[68:71], v12 offset:4800
    s_waitcnt lgkmcnt(9)
    v_mfma_f32_16x16x32_bf16 v[32:35], v[168:171], v[72:75], v[32:35]
    ds_read_b128 v[72:75], v12 offset:4864
    s_waitcnt lgkmcnt(9)
    v_mfma_f32_16x16x32_bf16 v[32:35], v[172:175], v[76:79], v[32:35]
    ds_read_b128 v[76:79], v12 offset:4928
    s_waitcnt lgkmcnt(9)
    v_mfma_f32_16x16x32_bf16 v[32:35], v[176:179], v[80:83], v[32:35]
    ds_read_b128 v[80:83], v12 offset:4992
    s_waitcnt lgkmcnt(9)
    v_mfma_f32_16x16x32_bf16 v[32:35], v[180:183], v[84:87], v[32:35]
    ds_read_b128 v[84:87], v12 offset:5056
    s_waitcnt lgkmcnt(5)
    v_mfma_f32_16x16x32_bf16 v[32:35], v[184:187], v[64:67], v[32:35]
    ds_read_b128 v[64:67], v12 offset:5120
    v_pk_add_f32 v[40:41], v[40:41], v[42:43]
    v_pk_add_f32 v[44:45], v[44:45], v[46:47]
    v_pk_add_f32 v[48:49], v[48:49], v[50:51]
    s_waitcnt lgkmcnt(5)
    v_mfma_f32_16x16x32_bf16 v[32:35], v[188:191], v[68:71], v[32:35]
    ds_read_b128 v[68:71], v12 offset:5184
    v_pk_add_f32 v[52:53], v[52:53], v[54:55]
    v_pk_add_f32 v[40:41], v[40:41], v[44:45]
    v_pk_add_f32 v[48:49], v[48:49], v[52:53]
    s_waitcnt lgkmcnt(5)
    v_mfma_f32_16x16x32_bf16 v[32:35], v[192:195], v[72:75], v[32:35]
    ds_read_b128 v[72:75], v12 offset:5248
    v_pk_add_f32 v[40:41], v[40:41], v[48:49]
    v_mul_f32 v60, 0x3b000000, v40
    v_mul_f32 v41, 0x3b000000, v41
    s_waitcnt lgkmcnt(5)
    v_mfma_f32_16x16x32_bf16 v[32:35], v[196:199], v[76:79], v[32:35]
    ds_read_b128 v[76:79], v12 offset:5312
    v_fma_f32 v41, -v60, v60, v41
    v_max_f32 v41, 0, v41
    v_cvt_pk_bf16_f32 v40, v60, v41
    s_waitcnt lgkmcnt(5)
    v_mfma_f32_16x16x32_bf16 v[32:35], v[200:203], v[80:83], v[32:35]
    v_lshlrev_b32 v60, 16, v40
    v_and_b32 v41, s52, v40
    v_add_f32 v41, 0x3727c5ac, v41
    s_waitcnt lgkmcnt(4)
    v_mfma_f32_16x16x32_bf16 v[32:35], v[204:207], v[84:87], v[32:35]
    v_cvt_pk_bf16_f32 v40, v41, v41
    v_and_b32 v41, s52, v40
    v_sqrt_f32 v41, v41
    s_waitcnt lgkmcnt(3)
    v_mfma_f32_16x16x32_bf16 v[32:35], v[208:211], v[64:67], v[32:35]
    v_cvt_pk_bf16_f32 v40, v41, v41
    v_and_b32 v41, s52, v40
    v_rcp_f32 v61, v41
    s_waitcnt lgkmcnt(2)
    v_mfma_f32_16x16x32_bf16 v[32:35], v[212:215], v[68:71], v[32:35]
    s_waitcnt lgkmcnt(1)
    v_mfma_f32_16x16x32_bf16 v[32:35], v[216:219], v[72:75], v[32:35]
    s_waitcnt lgkmcnt(0)
    v_mfma_f32_16x16x32_bf16 v[32:35], v[220:223], v[76:79], v[32:35]
    s_nop 7
    v_fma_f32 v32, -v60, v112, v32
    v_fma_f32 v33, -v60, v113, v33
    v_fma_f32 v34, -v60, v114, v34
    v_fma_f32 v35, -v60, v115, v35
    v_fma_f32 v32, v32, v61, v116
    v_fma_f32 v33, v33, v61, v117
    v_fma_f32 v34, v34, v61, v118
    v_fma_f32 v35, v35, v61, v119
    v_mov_b32 v36, v32
    v_mov_b32 v37, v33
    v_mov_b32 v38, v34
    v_mov_b32 v39, v35
    v_permlane32_swap_b32 v32, v36
    v_permlane32_swap_b32 v33, v37
    v_permlane32_swap_b32 v34, v38
    v_permlane32_swap_b32 v35, v39
    v_max_f32 v32, 0, v32
    v_max_f32 v33, 0, v33
    v_max_f32 v34, 0, v34
    v_max_f32 v35, 0, v35
    v_mul_f32 v32, v32, v36
    v_mul_f32 v33, v33, v37
    v_mul_f32 v34, v34, v38
    v_mul_f32 v35, v35, v39
    v_cvt_pk_bf16_f32 v36, v32, v33
    v_cvt_pk_bf16_f32 v37, v34, v35
    s_mov_b32 exec_lo, 0x000f000f
    s_mov_b32 exec_hi, 0
    ds_write_b64 v240, v[36:37] offset:8960
    s_mov_b64 exec, -1
    s_waitcnt lgkmcnt(0)
    s_barrier
    ds_read_b128 v[64:67], v241 offset:8960
    ds_read_b128 v[68:71], v241 offset:9024
    s_waitcnt lgkmcnt(0)
    v_mfma_f32_16x16x32_bf16 v[32:35], v[128:131], v[64:67], 0
    v_mfma_f32_16x16x32_bf16 v[36:39], v[132:135], v[64:67], 0
    v_mfma_f32_16x16x32_bf16 v[40:43], v[136:139], v[64:67], 0
    v_mfma_f32_16x16x32_bf16 v[44:47], v[140:143], v[64:67], 0
    v_mfma_f32_16x16x32_bf16 v[32:35], v[144:147], v[68:71], v[32:35]
    v_mfma_f32_16x16x32_bf16 v[36:39], v[148:151], v[68:71], v[36:39]
    v_mfma_f32_16x16x32_bf16 v[40:43], v[152:155], v[68:71], v[40:43]
    v_mfma_f32_16x16x32_bf16 v[44:47], v[156:159], v[68:71], v[44:47]
    s_nop 4
    v_cvt_pk_bf16_f32 v72, v32, v33
    v_cvt_pk_bf16_f32 v73, v34, v35
    v_cvt_pk_bf16_f32 v74, v36, v37
    v_cvt_pk_bf16_f32 v75, v38, v39
    v_cvt_pk_bf16_f32 v76, v40, v41
    v_cvt_pk_bf16_f32 v77, v42, v43
    v_cvt_pk_bf16_f32 v78, v44, v45
    v_cvt_pk_bf16_f32 v79, v46, v47
    v_min_u32 v72, -2, v72
    v_min_u32 v73, -2, v73
    v_min_u32 v74, -2, v74
    v_min_u32 v75, -2, v75
    v_min_u32 v76, -2, v76
    v_min_u32 v77, -2, v77
    v_min_u32 v78, -2, v78
    v_min_u32 v79, -2, v79
    s_mov_b64 exec, s[62:63]
    global_store_dwordx2 v242, v[72:73], s[14:15] offset:0 sc1
    global_store_dwordx2 v242, v[74:75], s[14:15] offset:128 sc1
    global_store_dwordx2 v243, v[76:77], s[14:15] offset:0 sc1
    global_store_dwordx2 v243, v[78:79], s[14:15] offset:128 sc1
    s_mov_b64 exec, -1
L_FIN_FFN:
    s_branch L_FIN
L_MODB:
    s_sub_u32 s66, s66, 44
    s_add_u32 s44, s66, 16
    v_lshlrev_b32 v4, 3, v0
    v_lshrrev_b32 v5, 3, v1
    s_mov_b32 s57, 6144
    v_mul_lo_u32 v20, s57, v5
    v_bfe_u32 v5, v1, 1, 2
    v_bfe_u32 v6, v1, 4, 1
    v_xor_b32 v5, v5, v6
    v_lshl_add_u32 v20, v5, 5, v20
    v_and_b32 v5, 1, v1
    v_lshl_add_u32 v20, v5, 4, v20
    v_xor_b32 v21, 64, v20
    v_mov_b32 v22, v20
    v_mov_b32 v23, v21
    s_mul_i32 s46, s3, 393216
    s_lshl_b32 s47, s44, 7
    s_add_u32 s46, s46, s47
    s_lshl_b32 s67, s3, 13
    s_add_u32 s67, s67, 17408
    s_waitcnt lgkmcnt(0)
    s_load_dword s7, s[42:43], 0
    s_add_u32 s8, s36, s46
    s_addc_u32 s9, s37, 0
    s_add_u32 s46, s46, 0
    s_add_u32 s12, s36, s46
    s_addc_u32 s13, s37, 0
    global_load_dwordx2 v[2:3], v4, s[34:35]
    v_min_u32 v227, 0, v1
    v_lshlrev_b32 v227, 2, v227
    global_load_dword v246, v227, s[38:39]
    s_cmp_lt_u32 s66, 16
    s_cbranch_scc0 L_modb_clr
    v_mov_b32 v24, -1
    v_mov_b32 v25, -1
    v_mov_b32 v26, -1
    v_mov_b32 v27, -1
    v_lshlrev_b32 v28, 4, v0
    v_lshlrev_b32 v29, 4, v1
    s_lshl_b32 s46, s66, 13
    s_add_u32 s46, s46, 131072
    s_add_u32 s48, s42, s46
    s_addc_u32 s49, s43, 0
    global_store_dwordx4 v28, v[24:27], s[48:49] sc1
    s_mul_i32 s46, s66, 7168
    s_add_u32 s46, s46, 327680
    s_lshl_b32 s47, s3, 10
    s_add_u32 s46, s46, s47
    s_lshl_b32 s47, s66, 10
    s_add_u32 s47, s47, 262144
    s_cmp_lt_u32 s3, 7
    s_cselect_b32 s46, s46, s47
    s_add_u32 s50, s42, s46
    s_addc_u32 s51, s43, 0
    global_store_dwordx4 v29, v[24:27], s[50:51] sc1
    s_cmp_lt_u32 s3, 2
    s_cbranch_scc0 L_modb_c2
    s_lshl_b32 s46, s66, 11
    s_lshl_b32 s47, s3, 10
    s_add_u32 s46, s46, s47
    s_add_u32 s46, s46, 278528
    s_add_u32 s50, s42, s46
    s_addc_u32 s51, s43, 0
    global_store_dwordx4 v29, v[24:27], s[50:51] sc1
L_modb_c2:
    s_waitcnt lgkmcnt(0)
    s_mul_i32 s6, s7, 1664525
    s_add_u32 s6, s6, 1013904223
    s_waitcnt vmcnt(0)
    s_barrier
    s_cmp_eq_u32 s3, 0
    s_cbranch_scc0 L_modb_clr
    s_lshl_b32 s46, s66, 7
    s_add_u32 s46, s46, 6144
    v_mov_b32 v28, s46
    v_mov_b32 v30, 0
    v_mov_b32 v31, s6
    s_mov_b64 exec, 1
    global_store_dwordx2 v28, v[30:31], s[42:43] sc1
    s_mov_b64 exec, -1
L_modb_clr:
    s_mov_b32 m0, s67
    s_nop 0
    global_load_lds_dwordx4 v20, s[8:9] nt
    s_add_u32 m0, s67, 1024
    v_add_u32 v21, 49152, v21
    global_load_lds_dwordx4 v21, s[8:9] nt
    s_add_u32 m0, s67, 2048
    v_add_u32 v20, 98304, v20
    global_load_lds_dwordx4 v20, s[8:9] nt
    s_add_u32 m0, s67, 3072
    v_add_u32 v21, 98304, v21
    global_load_lds_dwordx4 v21, s[8:9] nt
    s_add_u32 m0, s67, 4096
    v_add_u32 v20, 98304, v20
    global_load_lds_dwordx4 v20, s[8:9] nt
    s_add_u32 m0, s67, 5120
    v_add_u32 v21, 98304, v21
    global_load_lds_dwordx4 v21, s[8:9] nt
    s_add_u32 m0, s67, 6144
    v_add_u32 v20, 98304, v20
    global_load_lds_dwordx4 v20, s[8:9] nt
    s_add_u32 m0, s67, 7168
    v_add_u32 v21, 98304, v21
    global_load_lds_dwordx4 v21, s[8:9] nt
    s_mov_b32 s53, 0x3fb8aa3b
    s_mov_b32 s54, 0xbfb8aa3b
    s_mov_b32 s55, 0x3db504f3
    s_mov_b32 s68, 0x00003f80
    s_mov_b32 s69, 0x3f800000
    v_lshrrev_b32 v4, 4, v1
    v_bfe_u32 v5, v1, 2, 2
    v_lshl_add_u32 v200, v4, 3, v5
    v_lshlrev_b32 v200, 7, v200
    v_and_b32 v4, 1, v4
    v_lshrrev_b32 v5, 1, v5
    v_lshl_add_u32 v4, v4, 1, v5
    s_and_b32 s57, s3, 3
    v_xor_b32 v4, s57, v4
    v_lshl_add_u32 v200, v4, 5, v200
    v_bfe_u32 v4, v1, 1, 1
    v_lshl_add_u32 v200, v4, 4, v200
    v_and_b32 v4, 1, v1
    v_lshl_add_u32 v200, v4, 3, v200
    v_add_u32 v200, 17408, v200
    v_add_u32 v201, 65536, v200
    v_and_b32 v4, 3, v1
    v_mul_u32_u24 v204, 1088, v4
    v_lshrrev_b32 v4, 4, v1
    v_lshl_add_u32 v204, v4, 4, v204
    v_and_b32 v4, 3, v1
    v_lshlrev_b32 v206, 6, v4
    v_lshrrev_b32 v4, 4, v1
    v_lshl_add_u32 v206, v4, 4, v206
    s_and_b32 s57, s3, 3
    s_lshl_b32 s57, s57, 8
    v_add_u32 v206, s57, v206
    s_lshl_b32 s46, s44, 10
    s_add_u32 s46, s46, 8192
    s_add_u32 s10, s42, s46
    s_addc_u32 s11, s43, 0
    s_add_u32 s46, s46, 0
    s_add_u32 s14, s42, s46
    s_addc_u32 s15, s43, 0
    s_waitcnt vmcnt(8)
    v_lshlrev_b32 v8, 16, v2
    v_and_b32 v9, s52, v2
    v_lshlrev_b32 v10, 16, v3
    v_and_b32 v11, s52, v3
    v_mul_f32 v12, s54, v8
    v_mul_f32 v13, s54, v9
    v_mul_f32 v14, s54, v10
    v_mul_f32 v15, s54, v11
    v_exp_f32 v12, v12
    v_exp_f32 v13, v13
    v_exp_f32 v14, v14
    v_exp_f32 v15, v15
    v_add_f32 v12, 1.0, v12
    v_add_f32 v13, 1.0, v13
    v_add_f32 v14, 1.0, v14
    v_add_f32 v15, 1.0, v15
    v_rcp_f32 v40, v12
    v_rcp_f32 v41, v13
    v_rcp_f32 v42, v14
    v_rcp_f32 v43, v15
    v_mul_f32 v44, v8, v40
    v_mul_f32 v45, v9, v41
    v_mul_f32 v46, v10, v42
    v_mul_f32 v47, v11, v43
    v_fma_f32 v12, -v44, v12, v8
    v_fma_f32 v13, -v45, v13, v9
    v_fma_f32 v14, -v46, v14, v10
    v_fma_f32 v15, -v47, v15, v11
    v_mul_f32 v12, v12, v40
    v_mul_f32 v13, v13, v41
    v_mul_f32 v14, v14, v42
    v_mul_f32 v15, v15, v43
    v_cmp_neq_f32 vcc, 0, v40
    s_nop 1
    v_cndmask_b32 v12, 0, v12, vcc
    v_cmp_neq_f32 vcc, 0, v41
    s_nop 1
    v_cndmask_b32 v13, 0, v13, vcc
    v_cmp_neq_f32 vcc, 0, v42
    s_nop 1
    v_cndmask_b32 v14, 0, v14, vcc
    v_cmp_neq_f32 vcc, 0, v43
    s_nop 1
    v_cndmask_b32 v15, 0, v15, vcc
    v_add_f32 v8, v44, v12
    v_add_f32 v9, v45, v13
    v_add_f32 v10, v46, v14
    v_add_f32 v11, v47, v15
    v_cvt_pk_bf16_f32 v12, v8, v9
    v_cvt_pk_bf16_f32 v13, v10, v11
    v_lshrrev_b32 v14, 7, v0
    v_and_b32 v15, 127, v0
    v_mul_u32_u24 v16, 1088, v14
    v_lshl_add_u32 v16, v15, 3, v16
    ds_write_b64 v16, v[12:13] offset:0
    s_waitcnt lgkmcnt(0)
    s_mul_i32 s6, s7, 1664525
    s_add_u32 s6, s6, 1013904223
    v_mov_b32 v37, s6
    v_mov_b32 v39, s6
    s_barrier
    s_cmp_lt_u32 s3, 4
    s_cbranch_scc0 L_modb_a
    ds_read_b128 v[128:131], v204 offset:0
    ds_read_b128 v[132:135], v204 offset:64
    ds_read_b128 v[136:139], v204 offset:128
    ds_read_b128 v[140:143], v204 offset:192
    ds_read_b128 v[144:147], v204 offset:256
    ds_read_b128 v[148:151], v204 offset:320
    ds_read_b128 v[152:155], v204 offset:384
    ds_read_b128 v[156:159], v204 offset:448
    s_waitcnt lgkmcnt(7)
    ds_read_b128 v[160:163], v204 offset:512
    ds_read_b128 v[164:167], v204 offset:576
    ds_read_b128 v[168:171], v204 offset:640
    ds_read_b128 v[172:175], v204 offset:704
    ds_read_b128 v[176:179], v204 offset:768
    ds_read_b128 v[180:183], v204 offset:832
    ds_read_b128 v[184:187], v204 offset:896
    ds_read_b128 v[188:191], v204 offset:960
L_modb_a:
    s_waitcnt vmcnt(0) lgkmcnt(0)
    s_barrier
    s_cmp_lt_u32 s3, 4
    s_cbranch_scc0 L_modb_b
    ds_read_b64_tr_b16 v[64:65], v200 offset:0
    ds_read_b64_tr_b16 v[66:67], v200 offset:512
    ds_read_b64_tr_b16 v[68:69], v200 offset:4096
    ds_read_b64_tr_b16 v[70:71], v200 offset:4608
    ds_read_b64_tr_b16 v[72:73], v200 offset:8192
    ds_read_b64_tr_b16 v[74:75], v200 offset:8704
    ds_read_b64_tr_b16 v[76:77], v200 offset:12288
    ds_read_b64_tr_b16 v[78:79], v200 offset:12800
    ds_read_b64_tr_b16 v[80:81], v200 offset:16384
    ds_read_b64_tr_b16 v[82:83], v200 offset:16896
    ds_read_b64_tr_b16 v[84:85], v200 offset:20480
    ds_read_b64_tr_b16 v[86:87], v200 offset:20992
    s_waitcnt lgkmcnt(10)
    v_mfma_f32_16x16x32_bf16 v[32:35], v[64:67], v[128:131], 0
    ds_read_b64_tr_b16 v[64:65], v200 offset:24576
    ds_read_b64_tr_b16 v[66:67], v200 offset:25088
    s_waitcnt lgkmcnt(10)
    v_mfma_f32_16x16x32_bf16 v[32:35], v[68:71], v[132:135], v[32:35]
    ds_read_b64_tr_b16 v[68:69], v200 offset:28672
    ds_read_b64_tr_b16 v[70:71], v200 offset:29184
    s_waitcnt lgkmcnt(10)
    v_mfma_f32_16x16x32_bf16 v[32:35], v[72:75], v[136:139], v[32:35]
    ds_read_b64_tr_b16 v[72:73], v200 offset:32768
    ds_read_b64_tr_b16 v[74:75], v200 offset:33280
    s_waitcnt lgkmcnt(10)
    v_mfma_f32_16x16x32_bf16 v[32:35], v[76:79], v[140:143], v[32:35]
    ds_read_b64_tr_b16 v[76:77], v200 offset:36864
    ds_read_b64_tr_b16 v[78:79], v200 offset:37376
    s_waitcnt lgkmcnt(10)
    v_mfma_f32_16x16x32_bf16 v[32:35], v[80:83], v[144:147], v[32:35]
    ds_read_b64_tr_b16 v[80:81], v200 offset:40960
    ds_read_b64_tr_b16 v[82:83], v200 offset:41472
    s_waitcnt lgkmcnt(10)
    v_mfma_f32_16x16x32_bf16 v[32:35], v[84:87], v[148:151], v[32:35]
    ds_read_b64_tr_b16 v[84:85], v200 offset:45056
    ds_read_b64_tr_b16 v[86:87], v200 offset:45568
    s_waitcnt lgkmcnt(10)
    v_mfma_f32_16x16x32_bf16 v[32:35], v[64:67], v[152:155], v[32:35]
    ds_read_b64_tr_b16 v[64:65], v200 offset:49152
    ds_read_b64_tr_b16 v[66:67], v200 offset:49664
    s_waitcnt lgkmcnt(10)
    v_mfma_f32_16x16x32_bf16 v[32:35], v[68:71], v[156:159], v[32:35]
    ds_read_b64_tr_b16 v[68:69], v200 offset:53248
    ds_read_b64_tr_b16 v[70:71], v200 offset:53760
    s_waitcnt lgkmcnt(10)
    v_mfma_f32_16x16x32_bf16 v[32:35], v[72:75], v[160:163], v[32:35]
    ds_read_b64_tr_b16 v[72:73], v200 offset:57344
    ds_read_b64_tr_b16 v[74:75], v200 offset:57856
    s_waitcnt lgkmcnt(10)
    v_mfma_f32_16x16x32_bf16 v[32:35], v[76:79], v[164:167], v[32:35]
    ds_read_b64_tr_b16 v[76:77], v200 offset:61440
    ds_read_b64_tr_b16 v[78:79], v200 offset:61952
    s_waitcnt lgkmcnt(10)
    v_mfma_f32_16x16x32_bf16 v[32:35], v[80:83], v[168:171], v[32:35]
    s_waitcnt lgkmcnt(8)
    v_mfma_f32_16x16x32_bf16 v[32:35], v[84:87], v[172:175], v[32:35]
    s_waitcnt lgkmcnt(6)
    v_mfma_f32_16x16x32_bf16 v[32:35], v[64:67], v[176:179], v[32:35]
    s_waitcnt lgkmcnt(4)
    v_mfma_f32_16x16x32_bf16 v[32:35], v[68:71], v[180:183], v[32:35]
    s_waitcnt lgkmcnt(2)
    v_mfma_f32_16x16x32_bf16 v[32:35], v[72:75], v[184:187], v[32:35]
    s_waitcnt lgkmcnt(0)
    v_mfma_f32_16x16x32_bf16 v[32:35], v[76:79], v[188:191], v[32:35]
    s_nop 7
    v_cvt_pk_bf16_f32 v36, v32, v33
    v_cvt_pk_bf16_f32 v38, v34, v35
    s_mov_b64 exec, s[62:63]
    global_store_dwordx4 v206, v[36:39], s[10:11] sc1
    s_mov_b64 exec, -1
L_modb_b:
    s_cmp_lt_u32 s66, 16
    s_cbranch_scc0 L_FIN_B
    v_lshrrev_b32 v2, 5, v1
    v_bfe_u32 v3, v1, 3, 2
    v_and_b32 v4, 7, v1
    s_lshl_b32 s46, s66, 6
    v_lshlrev_b32 v180, 10, v3
    v_lshl_add_u32 v180, v2, 5, v180
    v_lshl_add_u32 v180, v4, 2, v180
    v_add_u32 v180, s46, v180
    s_lshl_b32 s46, s66, 9
    v_lshlrev_b32 v5, 8, v2
    v_lshl_add_u32 v5, v3, 6, v5
    v_lshl_add_u32 v5, v4, 3, v5
    v_add_u32 v5, s46, v5
    s_lshl_b32 s46, s66, 8
    v_lshlrev_b32 v6, 7, v2
    v_lshl_add_u32 v6, v3, 5, v6
    v_lshl_add_u32 v6, v4, 2, v6
    v_add_u32 v6, s46, v6
    v_add_u32 v11, 8192, v6
    s_add_u32 s8, s42, 0x6000
    s_addc_u32 s9, s43, 0
    s_add_u32 s10, s42, 0xc000
    s_addc_u32 s11, s43, 0
    s_add_u32 s14, s42, 0x45000
    s_addc_u32 s15, s43, 0
    s_add_u32 s48, s42, 0x49000
    s_addc_u32 s49, s43, 0
    s_mul_i32 s46, s66, 7168
    s_add_u32 s46, s46, 327680
    s_add_u32 s50, s42, s46
    s_addc_u32 s51, s43, 0
    v_lshlrev_b32 v7, 3, v0
    v_add_u32 v8, 4096, v7
    v_lshlrev_b32 v9, 4, v1
    s_lshl_b32 s46, s3, 9
    s_add_u32 s46, s46, 8960
    v_add_u32 v9, s46, v9
    v_lshlrev_b32 v10, 3, v1
    s_cmp_eq_u32 s3, 0
    s_cbranch_scc0 L_fin_a
    global_load_dword v181, v180, s[16:17]
    v_and_b32 v40, 15, v1
    v_lshlrev_b32 v40, 7, v40
    v_add_u32 v40, 6144, v40
L_poll_21:
    global_load_dwordx2 v[42:43], v40, s[42:43] sc1
    s_waitcnt vmcnt(0)
    v_cmp_eq_u32 vcc, s6, v43
    s_cmp_eq_u64 vcc, exec
    s_cbranch_scc0 L_retry_22
L_poll_23:
    global_load_dwordx2 v[12:13], v5, s[8:9] sc1
    global_load_dwordx2 v[14:15], v5, s[10:11] sc1
    s_waitcnt vmcnt(0)
    v_cmp_eq_u32 vcc, s6, v13
    v_cmp_eq_u32 s[60:61], s6, v15
    s_and_b64 vcc, vcc, s[60:61]
    s_cmp_eq_u64 vcc, exec
    s_cbranch_scc0 L_retry_24
    global_load_dword v16, v6, s[14:15] offset:-4096 sc1
    global_load_dword v17, v6, s[14:15] offset:0 sc1
    global_load_dword v18, v11, s[14:15] offset:-4096 sc1
    global_load_dword v19, v11, s[14:15] offset:0 sc1
    global_load_dword v20, v6, s[48:49] offset:-4096 sc1
    global_load_dword v21, v6, s[48:49] offset:0 sc1
    global_load_dword v22, v11, s[48:49] offset:-4096 sc1
    global_load_dword v23, v11, s[48:49] offset:0 sc1
L_schk_25:
    s_waitcnt vmcnt(0)
    v_cmp_eq_u32 s[88:89], -1, v16
    v_cmp_eq_u32 s[90:91], -1, v17
    s_or_b64 s[60:61], s[88:89], s[90:91]
    v_cmp_eq_u32 s[92:93], -1, v18
    s_or_b64 s[60:61], s[60:61], s[92:93]
    v_cmp_eq_u32 s[94:95], -1, v19
    s_or_b64 s[60:61], s[60:61], s[94:95]
    v_cmp_eq_u32 s[96:97], -1, v20
    s_or_b64 s[60:61], s[60:61], s[96:97]
    v_cmp_eq_u32 s[98:99], -1, v21
    s_or_b64 s[60:61], s[60:61], s[98:99]
    v_cmp_eq_u32 s[26:27], -1, v22
    s_or_b64 s[60:61], s[60:61], s[26:27]
    v_cmp_eq_u32 s[0:1], -1, v23
    s_or_b64 s[60:61], s[60:61], s[0:1]
    s_cmp_lg_u64 s[60:61], 0
    s_cbranch_scc1 L_sretry_26
    v_lshlrev_b32 v36, 16, v16
    v_and_b32 v37, s52, v16
    v_dot2c_f32_bf16 v36, s68, v17
    v_dot2c_f32_bf16 v37, s69, v17
    v_dot2c_f32_bf16 v36, s68, v18
    v_dot2c_f32_bf16 v37, s69, v18
    v_dot2c_f32_bf16 v36, s68, v19
    v_dot2c_f32_bf16 v37, s69, v19
    v_dot2c_f32_bf16 v36, s68, v20
    v_dot2c_f32_bf16 v37, s69, v20
    v_dot2c_f32_bf16 v36, s68, v21
    v_dot2c_f32_bf16 v37, s69, v21
    v_dot2c_f32_bf16 v36, s68, v22
    v_dot2c_f32_bf16 v37, s69, v22
    v_dot2c_f32_bf16 v36, s68, v23
    v_dot2c_f32_bf16 v37, s69, v23
    v_lshlrev_b32 v38, 16, v12
    v_and_b32 v39, s52, v12
    v_lshlrev_b32 v182, 16, v181
    v_and_b32 v183, s52, v181
    v_fmac_f32 v182, v36, v38
    v_fmac_f32 v183, v37, v39
    v_lshlrev_b32 v184, 16, v14
    v_and_b32 v185, s52, v14
L_fin_a:
    s_cmp_lt_u32 s3, 6
    s_cbranch_scc0 L_fin_one
    global_load_dwordx2 v[40:41], v7, s[50:51] sc1
    global_load_dwordx2 v[42:43], v8, s[50:51] sc1
L_schk_27:
    s_waitcnt vmcnt(0)
    v_max_u32 v254, v40, v41
    v_cmp_eq_u32 s[88:89], -1, v254
    v_max_u32 v254, v42, v43
    v_cmp_eq_u32 s[90:91], -1, v254
    s_or_b64 s[60:61], s[88:89], s[90:91]
    s_cmp_lg_u64 s[60:61], 0
    s_cbranch_scc1 L_sretry_28
    v_lshlrev_b32 v48, 16, v40
    v_and_b32 v49, s52, v40
    v_lshlrev_b32 v50, 16, v41
    v_and_b32 v51, s52, v41
    v_dot2c_f32_bf16 v48, s68, v42
    v_dot2c_f32_bf16 v49, s69, v42
    v_dot2c_f32_bf16 v50, s68, v43
    v_dot2c_f32_bf16 v51, s69, v43
    s_branch L_fin_b
L_fin_one:
    global_load_dwordx2 v[40:41], v7, s[50:51] sc1
L_schk_29:
    s_waitcnt vmcnt(0)
    v_max_u32 v254, v40, v41
    v_cmp_eq_u32 s[88:89], -1, v254
    s_cmp_lg_u64 s[88:89], 0
    s_cbranch_scc1 L_sretry_30
    v_lshlrev_b32 v48, 16, v40
    v_and_b32 v49, s52, v40
    v_lshlrev_b32 v50, 16, v41
    v_and_b32 v51, s52, v41
L_fin_b:
    v_mov_b32 v52, v48
    v_mov_b32 v53, v49
    v_mov_b32 v54, v50
    v_mov_b32 v55, v51
    v_permlane32_swap_b32 v48, v52
    v_permlane32_swap_b32 v49, v53
    v_permlane32_swap_b32 v50, v54
    v_permlane32_swap_b32 v51, v55
    v_pk_add_f32 v[48:49], v[48:49], v[52:53]
    v_pk_add_f32 v[50:51], v[50:51], v[54:55]
    s_mov_b32 exec_hi, 0
    ds_write_b128 v9, v[48:51]
    s_mov_b64 exec, -1
    s_waitcnt lgkmcnt(0)
    s_barrier
    s_cmp_eq_u32 s3, 0
    s_cbranch_scc0 L_FIN_B
    ds_read_b64 v[64:65], v10 offset:8960
    ds_read_b64 v[66:67], v10 offset:9472
    ds_read_b64 v[68:69], v10 offset:9984
    ds_read_b64 v[70:71], v10 offset:10496
    ds_read_b64 v[72:73], v10 offset:11008
    ds_read_b64 v[74:75], v10 offset:11520
    ds_read_b64 v[76:77], v10 offset:12032
    ds_read_b64 v[78:79], v10 offset:12544
    s_waitcnt lgkmcnt(0)
    v_pk_add_f32 v[64:65], v[64:65], v[66:67]
    v_pk_add_f32 v[68:69], v[68:69], v[70:71]
    v_pk_add_f32 v[72:73], v[72:73], v[74:75]
    v_pk_add_f32 v[76:77], v[76:77], v[78:79]
    v_pk_add_f32 v[64:65], v[64:65], v[68:69]
    v_pk_add_f32 v[72:73], v[72:73], v[76:77]
    v_pk_add_f32 v[64:65], v[64:65], v[72:73]
    v_fmac_f32 v182, v64, v184
    v_fmac_f32 v183, v65, v185
    v_cvt_pk_bf16_f32 v64, v182, v183
    global_store_dword v180, v64, s[38:39]
    s_cmp_eq_u32 s66, 0
    s_cbranch_scc0 L_FIN_B
    s_mov_b64 exec, 1
    v_mov_b32 v2, 0
    v_mov_b32 v3, s6
    global_store_dword v2, v3, s[42:43] offset:0
    s_mov_b64 exec, -1
L_FIN_B:
L_FIN:
L_END:
    s_endpgm
L_qsr_10:
    s_add_u32 s56, s56, 1
    s_cmp_lt_u32 s56, 40000
    s_cbranch_scc1 L_qs_9
    s_mov_b32 s2, s46
    s_mov_b32 s3, s44
    s_mov_b32 s57, 2
    s_branch L_FAIL
L_tretry_3:
    s_mov_b64 exec, s[88:89]
    global_load_dwordx4 v[8:11], v208, s[10:11] offset:-4096 sc1
    s_mov_b64 exec, s[90:91]
    global_load_dwordx4 v[12:15], v209, s[10:11] sc1
    s_mov_b64 exec, -1
    s_add_u32 s56, s56, 1
    s_cmp_lt_u32 s56, 40000
    s_cbranch_scc1 L_tchk_2
    s_mov_b32 s57, 1
    s_branch L_FAIL
L_sretry_7:
    s_mov_b64 exec, s[88:89]
    global_load_dwordx2 v[64:65], v5, s[8:9] offset:0 sc1
    s_mov_b64 exec, s[90:91]
    global_load_dwordx2 v[66:67], v5, s[8:9] offset:1024 sc1
    s_mov_b64 exec, s[92:93]
    global_load_dwordx2 v[68:69], v5, s[8:9] offset:2048 sc1
    s_mov_b64 exec, s[94:95]
    global_load_dwordx2 v[70:71], v5, s[8:9] offset:3072 sc1
    s_mov_b64 exec, s[96:97]
    global_load_dword v80, v6, s[10:11] offset:0 sc1
    s_mov_b64 exec, s[98:99]
    global_load_dword v81, v6, s[10:11] offset:128 sc1
    s_mov_b64 exec, s[26:27]
    global_load_dword v82, v6, s[10:11] offset:256 sc1
    s_mov_b64 exec, s[0:1]
    global_load_dword v83, v6, s[10:11] offset:384 sc1
    s_mov_b64 exec, -1
    s_add_u32 s56, s56, 1
    s_cmp_lt_u32 s56, 40000
    s_cbranch_scc1 L_schk_6
    s_mov_b32 s57, 3
    s_branch L_FAIL
L_tretry_12:
    s_mov_b64 exec, s[88:89]
    global_load_dwordx2 v[210:211], v209, s[42:43] sc1
    s_mov_b64 exec, -1
    s_add_u32 s56, s56, 1
    s_cmp_lt_u32 s56, 40000
    s_cbranch_scc1 L_tchk_11
    s_mov_b32 s57, 15
    s_branch L_FAIL
L_tretry_18:
    s_mov_b64 exec, s[88:89]
    global_load_dwordx4 v[48:51], v5, s[8:9] offset:-4096 sc1
    s_mov_b64 exec, s[90:91]
    global_load_dwordx4 v[52:55], v15, s[8:9] offset:-4096 sc1
    s_mov_b64 exec, s[92:93]
    global_load_dwordx4 v[56:59], v17, s[8:9] offset:-4096 sc1
    s_mov_b64 exec, -1
    s_add_u32 s56, s56, 1
    s_cmp_lt_u32 s56, 40000
    s_cbranch_scc1 L_tchk_17
    s_mov_b32 s57, 4
    s_branch L_FAIL
L_sretry_20:
    s_mov_b64 exec, s[88:89]
    global_load_dwordx2 v[96:97], v8, s[10:11] offset:-4096 sc1
    s_mov_b64 exec, s[90:91]
    global_load_dwordx2 v[98:99], v8, s[10:11] offset:0 sc1
    s_mov_b64 exec, s[92:93]
    global_load_dwordx2 v[100:101], v18, s[10:11] offset:-4096 sc1
    s_mov_b64 exec, s[94:95]
    global_load_dwordx2 v[102:103], v18, s[10:11] offset:0 sc1
    s_mov_b64 exec, s[96:97]
    global_load_dwordx2 v[104:105], v8, s[12:13] offset:-4096 sc1
    s_mov_b64 exec, s[98:99]
    global_load_dwordx2 v[106:107], v8, s[12:13] offset:0 sc1
    s_mov_b64 exec, s[26:27]
    global_load_dwordx2 v[108:109], v18, s[12:13] offset:-4096 sc1
    s_mov_b64 exec, s[0:1]
    global_load_dwordx2 v[110:111], v18, s[12:13] offset:0 sc1
    s_mov_b64 exec, -1
    s_add_u32 s56, s56, 1
    s_cmp_lt_u32 s56, 40000
    s_cbranch_scc1 L_schk_19
    s_mov_b32 s57, 5
    s_branch L_FAIL
L_sretry_26:
    s_mov_b64 exec, s[88:89]
    global_load_dword v16, v6, s[14:15] offset:-4096 sc1
    s_mov_b64 exec, s[90:91]
    global_load_dword v17, v6, s[14:15] offset:0 sc1
    s_mov_b64 exec, s[92:93]
    global_load_dword v18, v11, s[14:15] offset:-4096 sc1
    s_mov_b64 exec, s[94:95]
    global_load_dword v19, v11, s[14:15] offset:0 sc1
    s_mov_b64 exec, s[96:97]
    global_load_dword v20, v6, s[48:49] offset:-4096 sc1
    s_mov_b64 exec, s[98:99]
    global_load_dword v21, v6, s[48:49] offset:0 sc1
    s_mov_b64 exec, s[26:27]
    global_load_dword v22, v11, s[48:49] offset:-4096 sc1
    s_mov_b64 exec, s[0:1]
    global_load_dword v23, v11, s[48:49] offset:0 sc1
    s_mov_b64 exec, -1
    s_add_u32 s56, s56, 1
    s_cmp_lt_u32 s56, 40000
    s_cbranch_scc1 L_schk_25
    s_mov_b32 s57, 11
    s_branch L_FAIL
L_sretry_28:
    s_mov_b64 exec, s[88:89]
    global_load_dwordx2 v[40:41], v7, s[50:51] sc1
    s_mov_b64 exec, s[90:91]
    global_load_dwordx2 v[42:43], v8, s[50:51] sc1
    s_mov_b64 exec, -1
    s_add_u32 s56, s56, 1
    s_cmp_lt_u32 s56, 40000
    s_cbranch_scc1 L_schk_27
    s_mov_b32 s57, 7
    s_branch L_FAIL
L_sretry_30:
    s_mov_b64 exec, s[88:89]
    global_load_dwordx2 v[40:41], v7, s[50:51] sc1
    s_mov_b64 exec, -1
    s_add_u32 s56, s56, 1
    s_cmp_lt_u32 s56, 40000
    s_cbranch_scc1 L_schk_29
    s_mov_b32 s57, 7
    s_branch L_FAIL
L_retry_5:
    s_add_u32 s56, s56, 1
    s_cmp_lt_u32 s56, 40000
    s_cbranch_scc1 L_poll_4
    s_mov_b32 s57, 14
    s_branch L_FAIL
L_retry_22:
    s_add_u32 s56, s56, 1
    s_cmp_lt_u32 s56, 40000
    s_cbranch_scc1 L_poll_21
    s_mov_b32 s57, 10
    s_branch L_FAIL
L_retry_24:
    s_add_u32 s56, s56, 1
    s_cmp_lt_u32 s56, 40000
    s_cbranch_scc1 L_poll_23
    s_mov_b32 s57, 6
    s_branch L_FAIL
L_FAIL:
    s_mov_b64 exec, 1
    s_lshl_b32 s58, s57, 2
    v_mov_b32 v2, s58
    s_lshl_b32 s59, s2, 8
    s_add_u32 s59, s59, s3
    s_add_u32 s59, s59, 0x10000
    v_mov_b32 v3, s59
    global_store_dword v2, v3, s[40:41]
    s_endpgm
L_CODE_END:

.section .rodata,"a"
.p2align 6
.amdhsa_kernel adaLN_cond__sliding_block_cached__glu_gated_reglu__decode_kernel
  .amdhsa_next_free_vgpr 256
  .amdhsa_next_free_sgpr 102
  .amdhsa_accum_offset 256
  .amdhsa_group_segment_fixed_size 0
  .amdhsa_kernarg_size 112
  .amdhsa_user_sgpr_count 2
  .amdhsa_user_sgpr_kernarg_segment_ptr 1
  .amdhsa_system_sgpr_workgroup_id_x 1
.end_amdhsa_kernel
```
